```python
import torch

def _softmax(x, axis=-1):
    return torch.softmax(x, dim=axis)
def _gelu(x):
    return torch.nn.functional.gelu(x, approximate="tanh")
def _silu(x):
    return torch.nn.functional.silu(x)
def _sigmoid(x):
    return torch.sigmoid(x)
def _layernorm(x, axis=-1, eps=1e-5):
    m = x.mean(dim=axis, keepdim=True)
    v = x.var(dim=axis, keepdim=True, unbiased=False)
    return (x - m) / torch.sqrt(v + eps)
def _scatter_add(tgt, idx, src, axis=0):
    return tgt.clone().index_add_(axis, idx, src)
def _segment_sum(src, seg, n):
    out = torch.zeros((n,) + src.shape[1:], dtype=src.dtype)
    return out.index_add_(0, seg, src)
def _pad(x, pw):
    flat = tuple(v for pair in reversed(pw) for v in pair)
    return torch.nn.functional.pad(x, flat)

kernel_name = 'parallel_sum__gqa_block_cached__swiglu_ffn__decode'

def setup_inputs():

    _w = (lambda a: (lambda t: t.to(torch.bfloat16) if t.is_floating_point() else t)(torch.as_tensor(a)))
    def _A_setup():
        B, Sq, D = 1, 1, 1024
        Hq, Hkv, Sk, Dh = 32, 4, 65536, 128
        assert Hq % Hkv == 0, (Hq, Hkv)
        return {
            "x": _w((lambda *s: torch.randn(*s, dtype=torch.bfloat16) * 0.05)(B, Sq, D)),
            "k_cache": _w((lambda *s: torch.randn(*s, dtype=torch.bfloat16) * 3.2)(B, Hkv, Sk, Dh)),
            "v_cache": _w((lambda *s: torch.randn(*s, dtype=torch.bfloat16) * 1.6)(B, Hkv, Sk, Dh)),
            "wq": _w((lambda *s: torch.randn(*s, dtype=torch.bfloat16) * 3.2)(D, Hq * Dh) * (D ** -0.5)),
            "wo": _w((lambda *s: torch.randn(*s, dtype=torch.bfloat16) * 1.6)(Hq * Dh, D) * ((Hq * Dh) ** -0.5)),
        }
    _A_in = _A_setup()

    def _B_setup():
        B, S, D, F = 1, 1, 1024, 3584
        return {
            "x": _w((lambda *s: torch.randn(*s, dtype=torch.bfloat16) * 0.05)(B, S, D)),
            "w_gate": _w((lambda *s: torch.randn(*s, dtype=torch.bfloat16) * 0.05)(D, F)),
            "w_up": _w((lambda *s: torch.randn(*s, dtype=torch.bfloat16) * 0.05)(D, F)),
            "w_down": _w((lambda *s: torch.randn(*s, dtype=torch.bfloat16) * 0.05)(F, D)),
        }
    _B_in = _B_setup()

    return {
        "A_x": _A_in["x"],
        "A_k_cache": _A_in["k_cache"],
        "A_v_cache": _A_in["v_cache"],
        "A_wq": _A_in["wq"],
        "A_wo": _A_in["wo"],
        "B_x": _B_in["x"],
        "B_w_gate": _B_in["w_gate"],
        "B_w_up": _B_in["w_up"],
        "B_w_down": _B_in["w_down"],
    }

def reference(A_x, A_k_cache, A_v_cache, A_wq, A_wo, B_x, B_w_gate, B_w_up, B_w_down):
    def _A_ref(x, k_cache, v_cache, wq, wo):
        B, Sq, D = x.shape
        Hq, Dh = 32, 128
        Hkv = k_cache.shape[1]
        rep = Hq // Hkv
        q = (lambda x, *d: x.permute(*d))((x @ wq).reshape(B, Sq, Hq, Dh), 0, 2, 1, 3)
        k = (lambda x, n, axis: torch.repeat_interleave(x, n, dim=axis))(k_cache, rep, axis=1)
        v = (lambda x, n, axis: torch.repeat_interleave(x, n, dim=axis))(v_cache, rep, axis=1)
        scores = torch.einsum("bhqd,bhkd->bhqk", q, k) * (Dh ** -0.5)
        p = _softmax(scores, axis=-1)
        o = torch.einsum("bhqk,bhkd->bhqd", p, v)
        return (lambda x, *d: x.permute(*d))(o, 0, 2, 1, 3).reshape(B, Sq, Hq * Dh) @ wo

    def _B_ref(x, w_gate, w_up, w_down):
        g = _silu(x @ w_gate)
        u = x @ w_up
        return (g * u) @ w_down

    x = A_x
    xn = _layernorm(x, axis=-1)
    return x + _A_ref(xn, A_k_cache, A_v_cache, A_wq, A_wo) + _B_ref(xn, B_w_gate, B_w_up, B_w_down)
```

```asm
; @launch grid=(256,1,1) block=(512,1,1) lds=155648
.amdgcn_target "amdgcn-amd-amdhsa--gfx950"
.text
.globl parallel_sum__gqa_block_cached__swiglu_ffn__decode_kernel
.p2align 8
.type parallel_sum__gqa_block_cached__swiglu_ffn__decode_kernel,@function
parallel_sum__gqa_block_cached__swiglu_ffn__decode_kernel:
    s_cmp_ge_u32 s2, 256
    s_cbranch_scc1 L_end
    s_load_dwordx16 s[4:19], s[0:1], 0
    s_load_dwordx8 s[20:27], s[0:1], 64
    v_lshrrev_b32 v12, 6, v0
    v_and_b32 v1, 63, v0
    v_readfirstlane_b32 s3, v12
    v_lshrrev_b32 v12, 3, v1
    v_and_b32 v13, 7, v1
    v_lshlrev_b32 v20, 4, v13
    v_lshrrev_b32 v23, 4, v1
    v_lshlrev_b32 v8, 2, v1
    v_mov_b32 v9, 0
    s_and_b32 s46, s2, 63
    s_lshr_b32 s47, s2, 6
    s_bfe_u32 s42, s2, 0x10003
    s_lshl_b32 s48, s47, 1
    s_add_u32 s42, s42, s48
    s_mul_i32 s42, s42, 7
    s_mov_b32 s45, 400000
    s_cmp_eq_u32 s3, 0
    s_cbranch_scc1 L_loader
    s_barrier
    s_branch L_notloader
L_loader:
    s_setprio 3
    ds_write_b32 v8, v9 offset:0
    ds_write_b32 v8, v9 offset:256
    v_mov_b32 v16, 0
    v_mov_b32 v17, 36
    v_mov_b32 v18, 40
    v_mov_b32 v19, 44
    v_mov_b32 v10, 544
    ds_write_b128 v9, v[16:19] offset:256
    ds_write_b32 v9, v10 offset:272
    v_lshl_add_u32 v2, v12, 18, v20
    s_bfe_u32 s61, s2, 0x20004
    s_lshl_b32 s66, s61, 21
    s_lshl_b32 s48, s47, 11
    s_add_u32 s66, s66, s48
    s_and_b32 s48, s2, 15
    s_lshl_b32 s48, s48, 7
    s_add_u32 s66, s66, s48
    s_mov_b32 s31, 0x20000
    s_mov_b32 s30, 8388608
    s_mov_b32 s65, 0
    s_mov_b32 s68, 0
    v_mov_b32 v24, 0
    s_mov_b32 s67, 8
    s_waitcnt lgkmcnt(0)
    s_barrier
    s_mov_b64 s[28:29], s[10:11]
L_wq:
    s_add_u32 m0, s65, 8192
    s_waitcnt vmcnt(21)
    buffer_load_dwordx4 v2, s[28:31], s66 offen offset:0 nt lds
    s_add_u32 s66, s66, 8192
    s_add_u32 m0, s65, 9216
    v_add_u32 v10, -20, v24
    s_waitcnt vmcnt(21)
    buffer_load_dwordx4 v2, s[28:31], s66 offen offset:0 nt lds
    ds_max_i32 v8, v10 offset:0
    s_add_u32 s66, s66, 8192
    s_add_u32 m0, s65, 10240
    s_waitcnt vmcnt(21)
    buffer_load_dwordx4 v2, s[28:31], s66 offen offset:0 nt lds
    s_add_u32 s66, s66, 8192
    s_add_u32 m0, s65, 11264
    s_waitcnt vmcnt(21)
    buffer_load_dwordx4 v2, s[28:31], s66 offen offset:0 nt lds
    s_add_u32 s66, s66, 8192
    v_add_u32 v24, 4, v24
    s_add_u32 s65, s65, 4096
    s_and_b32 s65, s65, 0x1ffff
    s_sub_u32 s67, s67, 1
    s_cmp_lg_u32 s67, 0
    s_cbranch_scc1 L_wq
    s_mov_b32 s48, 229376
    v_mad_u32_u24 v3, v12, s48, v20
    v_bfe_u32 v4, v1, 1, 1
    v_bfe_u32 v25, v1, 2, 2
    v_lshl_add_u32 v4, v4, 2, v25
    v_lshlrev_b32 v4, 9, v4
    v_and_b32 v25, 1, v1
    v_lshl_add_u32 v4, v25, 6, v4
    v_lshl_add_u32 v4, v23, 4, v4
    v_and_b32 v5, 15, v1
    v_lshlrev_b32 v5, 4, v5
    v_lshl_add_u32 v5, v23, 9, v5
    v_and_b32 v6, 3, v12
    v_lshlrev_b32 v6, 4, v6
    v_lshrrev_b32 v25, 5, v1
    v_add_u32 v6, v6, v25
    v_lshl_add_u32 v6, v6, 14, v20
    v_lshl_add_u32 v7, v12, 11, v20
    s_mov_b32 s69, 32
    s_mov_b32 s30, 0x4000000
    s_lshr_b32 s63, s2, 3
    s_lshl_b32 s48, s63, 7
    s_add_u32 s48, s48, 720896
    s_add_u32 s38, s26, s48
    s_addc_u32 s39, s27, 0
    s_lshl_b32 s62, s63, 21
    s_and_b32 s48, s48, -1
    s_add_u32 s36, s26, s48
    s_addc_u32 s37, s27, 0
    s_mul_i32 s61, s61, 1835008
    s_mov_b32 s35, 0
    s_mov_b32 s70, s2
    s_lshr_b32 s71, s70, 1
    s_lshl_b32 s71, s71, 19
    s_and_b32 s70, s70, 1
    s_mov_b32 s33, 0
    s_mov_b64 s[28:29], s[6:7]
L_kr:
    s_lshl_b32 s48, s70, 8
    s_lshl_b32 s66, s33, 15
    s_add_u32 s66, s66, s48
    s_add_u32 s66, s66, s71
    s_mov_b32 s67, 4
    s_add_u32 s48, s69, -112
    s_add_u32 s69, s69, 16
    s_cmp_ge_i32 s68, s48
    s_cbranch_scc1 L_kc_f
L_kc_r:
    ds_read_b128 v[16:19], v9 offset:256
    ds_read_b32 v21, v9 offset:272
    s_waitcnt lgkmcnt(0)
    v_min3_i32 v16, v16, v17, v18
    v_min3_i32 v16, v16, v19, v21
    s_nop 0
    v_readfirstlane_b32 s68, v16
    s_cmp_ge_i32 s68, s48
    s_cbranch_scc1 L_kc_f
    s_sub_u32 s45, s45, 1
    s_cbranch_scc0 L_kc_r
    s_mov_b32 s45, 0
L_kc_f:
L_kb:
    s_add_u32 m0, s65, 8192
    s_waitcnt vmcnt(21)
    buffer_load_dwordx4 v4, s[28:31], s66 offen offset:0 nt lds
    s_add_u32 m0, s65, 9088
    v_add_u32 v10, -20, v24
    s_waitcnt vmcnt(21)
    buffer_load_dwordx4 v4, s[28:31], s66 offen offset:128 nt lds
    ds_max_i32 v8, v10 offset:0
    s_add_u32 s66, s66, 4096
    s_add_u32 m0, s65, 10240
    s_waitcnt vmcnt(21)
    buffer_load_dwordx4 v4, s[28:31], s66 offen offset:0 nt lds
    s_add_u32 m0, s65, 11136
    s_waitcnt vmcnt(21)
    buffer_load_dwordx4 v4, s[28:31], s66 offen offset:128 nt lds
    s_add_u32 s66, s66, 4096
    v_add_u32 v24, 4, v24
    s_add_u32 s65, s65, 4096
    s_and_b32 s65, s65, 0x1ffff
    s_sub_u32 s67, s67, 1
    s_cmp_lg_u32 s67, 0
    s_cbranch_scc1 L_kb
    s_add_u32 s33, s33, 1
    s_cmp_lt_u32 s33, 16
    s_cbranch_scc1 L_kr
    s_mov_b32 s33, 0
    s_mov_b64 s[28:29], s[8:9]
L_vr:
    s_lshl_b32 s48, s70, 8
    s_lshl_b32 s66, s33, 15
    s_add_u32 s66, s66, s48
    s_add_u32 s66, s66, s71
    s_mov_b32 s67, 4
    s_add_u32 s48, s69, -112
    s_add_u32 s69, s69, 16
    s_cmp_ge_i32 s68, s48
    s_cbranch_scc1 L_vc_f
L_vc_r:
    ds_read_b128 v[16:19], v9 offset:256
    ds_read_b32 v21, v9 offset:272
    s_waitcnt lgkmcnt(0)
    v_min3_i32 v16, v16, v17, v18
    v_min3_i32 v16, v16, v19, v21
    s_nop 0
    v_readfirstlane_b32 s68, v16
    s_cmp_ge_i32 s68, s48
    s_cbranch_scc1 L_vc_f
    s_sub_u32 s45, s45, 1
    s_cbranch_scc0 L_vc_r
    s_mov_b32 s45, 0
L_vc_f:
    s_cmp_lg_u32 s33, 15
    s_cbranch_scc1 L_vb
L_qr:
    ds_read_b32 v16, v9 offset:280
    s_waitcnt lgkmcnt(0)
    v_cmp_eq_u32 vcc, 0, v16
    s_cbranch_vccz L_qrd
    s_sub_u32 s45, s45, 1
    s_cbranch_scc0 L_qr
    s_mov_b32 s45, 0
L_qrd:
    ds_read_b128 v[16:19], v9 offset:256
    ds_read_b32 v21, v9 offset:272
    s_waitcnt lgkmcnt(0)
    v_min3_i32 v16, v16, v17, v18
    v_min3_i32 v16, v16, v19, v21
    s_nop 0
    v_readfirstlane_b32 s68, v16
    s_mov_b32 s35, 1
    s_atomic_add s35, s[36:37], 0 glc
L_vb:
    s_add_u32 m0, s65, 8192
    s_waitcnt vmcnt(21)
    buffer_load_dwordx4 v5, s[28:31], s66 offen offset:0 nt lds
    s_add_u32 s66, s66, 2048
    s_add_u32 m0, s65, 9216
    v_add_u32 v10, -20, v24
    s_waitcnt vmcnt(21)
    buffer_load_dwordx4 v5, s[28:31], s66 offen offset:0 nt lds
    ds_max_i32 v8, v10 offset:0
    s_add_u32 s66, s66, 2048
    s_add_u32 m0, s65, 10240
    s_waitcnt vmcnt(21)
    buffer_load_dwordx4 v5, s[28:31], s66 offen offset:0 nt lds
    s_add_u32 s66, s66, 2048
    s_add_u32 m0, s65, 11264
    s_waitcnt vmcnt(21)
    buffer_load_dwordx4 v5, s[28:31], s66 offen offset:0 nt lds
    s_add_u32 s66, s66, 2048
    v_add_u32 v24, 4, v24
    s_add_u32 s65, s65, 4096
    s_and_b32 s65, s65, 0x1ffff
    s_sub_u32 s67, s67, 1
    s_cmp_lg_u32 s67, 0
    s_cbranch_scc1 L_vb
    s_add_u32 s33, s33, 1
    s_cmp_lt_u32 s33, 16
    s_cbranch_scc1 L_vr
    s_mov_b32 s33, 0
    s_mov_b32 s30, 7340032
    v_mov_b32 v22, 320
L_gr:
    ds_read_b128 v[16:19], v9 offset:256
    ds_read_b32 v21, v9 offset:272
    s_waitcnt lgkmcnt(0)
    v_min3_i32 v16, v16, v17, v18
    v_min3_i32 v16, v16, v19, v21
    s_nop 0
    v_readfirstlane_b32 s68, v16
    s_cmp_ge_u32 s35, 28
    s_cbranch_scc1 L_gend
    s_add_u32 s48, s35, 1
    v_mov_b32 v16, s48
    ds_write_b32 v22, v16
    v_add_u32 v22, 4, v22
    s_lshr_b32 s48, s35, 2
    s_add_u32 s48, s48, s42
    s_lshl_b32 s48, s48, 7
    s_add_u32 s66, s61, s48
    s_bfe_u32 s48, s35, 0x10001
    s_mul_i32 s48, s48, 114688
    s_add_u32 s66, s66, s48
    s_bitcmp1_b32 s35, 0
    s_cselect_b64 s[28:29], s[18:19], s[16:17]
    s_add_u32 s33, s33, 1
    s_mov_b32 s67, 4
    s_mov_b32 s34, s35
    s_add_u32 s48, s69, -112
    s_add_u32 s69, s69, 16
    s_cmp_ge_i32 s68, s48
    s_cbranch_scc1 L_gc_f
L_gc_r:
    ds_read_b128 v[16:19], v9 offset:256
    ds_read_b32 v21, v9 offset:272
    s_waitcnt lgkmcnt(0)
    v_min3_i32 v16, v16, v17, v18
    v_min3_i32 v16, v16, v19, v21
    s_nop 0
    v_readfirstlane_b32 s68, v16
    s_cmp_ge_i32 s68, s48
    s_cbranch_scc1 L_gc_f
    s_sub_u32 s45, s45, 1
    s_cbranch_scc0 L_gc_r
    s_mov_b32 s45, 0
L_gc_f:
    s_mov_b32 s35, 28
    s_cmp_eq_u32 s33, 7
    s_cbranch_scc1 L_gb0
    s_mov_b32 s35, 1
    s_atomic_add s35, s[36:37], 0 glc
L_gb0:
L_gb:
    s_add_u32 m0, s65, 8192
    s_waitcnt vmcnt(19)
    buffer_load_dwordx4 v3, s[28:31], s66 offen offset:0 nt lds
    s_add_u32 s66, s66, 7168
    s_add_u32 m0, s65, 9216
    s_waitcnt vmcnt(19)
    buffer_load_dwordx4 v3, s[28:31], s66 offen offset:0 nt lds
    s_add_u32 s66, s66, 7168
    s_add_u32 m0, s65, 10240
    s_waitcnt vmcnt(19)
    buffer_load_dwordx4 v3, s[28:31], s66 offen offset:0 nt lds
    s_add_u32 s66, s66, 7168
    s_add_u32 m0, s65, 11264
    v_add_u32 v10, -16, v24
    s_waitcnt vmcnt(19)
    buffer_load_dwordx4 v3, s[28:31], s66 offen offset:0 nt lds
    ds_max_i32 v8, v10 offset:0
    s_add_u32 s66, s66, 7168
    v_add_u32 v24, 4, v24
    s_add_u32 s65, s65, 4096
    s_and_b32 s65, s65, 0x1ffff
    s_sub_u32 s67, s67, 1
    s_cmp_lg_u32 s67, 0
    s_cbranch_scc1 L_gb
    s_branch L_gr
L_gend:
    v_mov_b32 v16, 0x100
    ds_write_b32 v22, v16
    v_mov_b32 v16, s69
    ds_write_b32 v9, v16 offset:276
    s_lshl_b32 s49, s47, 9
    s_lshr_b32 s66, s46, 3
    s_lshl_b32 s66, s66, 9
    s_and_b32 s48, s46, 7
    s_add_u32 s66, s66, s48
    s_lshl_b32 s66, s66, 11
    s_add_u32 s66, s66, s49
    s_mov_b64 s[28:29], s[12:13]
    s_mov_b32 s30, 8388608
    s_mov_b32 s34, 0
    s_add_u32 s48, s69, -96
    s_add_u32 s69, s69, 32
    s_cmp_ge_i32 s68, s48
    s_cbranch_scc1 L_oc_f
L_oc_r:
    ds_read_b128 v[16:19], v9 offset:256
    ds_read_b32 v21, v9 offset:272
    s_waitcnt lgkmcnt(0)
    v_min3_i32 v16, v16, v17, v18
    v_min3_i32 v16, v16, v19, v21
    s_nop 0
    v_readfirstlane_b32 s68, v16
    s_cmp_ge_i32 s68, s48
    s_cbranch_scc1 L_oc_f
    s_sub_u32 s45, s45, 1
    s_cbranch_scc0 L_oc_r
    s_mov_b32 s45, 0
L_oc_f:
    s_mov_b32 s67, 4
L_oh:
L_wo:
    s_add_u32 m0, s65, 8192
    s_waitcnt vmcnt(19)
    buffer_load_dwordx4 v6, s[28:31], s66 offen offset:0 nt lds
    s_add_u32 m0, s65, 9088
    s_waitcnt vmcnt(19)
    buffer_load_dwordx4 v6, s[28:31], s66 offen offset:128 nt lds
    s_add_u32 m0, s65, 9984
    s_waitcnt vmcnt(19)
    buffer_load_dwordx4 v6, s[28:31], s66 offen offset:256 nt lds
    s_add_u32 m0, s65, 10880
    v_add_u32 v10, -16, v24
    s_waitcnt vmcnt(19)
    buffer_load_dwordx4 v6, s[28:31], s66 offen offset:384 nt lds
    ds_max_i32 v8, v10 offset:0
    s_add_u32 s66, s66, 32768
    v_add_u32 v24, 4, v24
    s_add_u32 s65, s65, 4096
    s_and_b32 s65, s65, 0x1ffff
    s_sub_u32 s67, s67, 1
    s_cmp_lg_u32 s67, 0
    s_cbranch_scc1 L_wo
    s_xor_b32 s34, s34, 1
    s_cbranch_scc0 L_od
    s_mov_b32 s35, 1
    s_atomic_add s35, s[38:39], 64 glc
    s_mov_b32 s67, 4
    s_branch L_oh
L_od:
    s_mul_i32 s60, s63, 229376
    s_add_u32 s30, s60, 229376
    s_mov_b64 s[28:29], s[20:21]
    s_mov_b32 s33, 0
    v_mov_b32 v22, 368
L_dr:
    ds_read_b128 v[16:19], v9 offset:256
    ds_read_b32 v21, v9 offset:272
    s_waitcnt lgkmcnt(0)
    v_min3_i32 v16, v16, v17, v18
    v_min3_i32 v16, v16, v19, v21
    s_nop 0
    v_readfirstlane_b32 s68, v16
    s_cmp_ge_u32 s35, 16
    s_cbranch_scc1 L_dend
    s_add_u32 s48, s35, 1
    v_mov_b32 v16, s48
    ds_write_b32 v22, v16
    v_add_u32 v22, 4, v22
    s_lshl_b32 s66, s35, 7
    s_add_u32 s66, s66, s60
    s_add_u32 s33, s33, 1
    s_mov_b32 s67, 4
    s_mov_b32 s34, s35
    s_add_u32 s48, s69, -112
    s_add_u32 s69, s69, 16
    s_cmp_ge_i32 s68, s48
    s_cbranch_scc1 L_dc_f
L_dc_r:
    ds_read_b128 v[16:19], v9 offset:256
    ds_read_b32 v21, v9 offset:272
    s_waitcnt lgkmcnt(0)
    v_min3_i32 v16, v16, v17, v18
    v_min3_i32 v16, v16, v19, v21
    s_nop 0
    v_readfirstlane_b32 s68, v16
    s_cmp_ge_i32 s68, s48
    s_cbranch_scc1 L_dc_f
    s_sub_u32 s45, s45, 1
    s_cbranch_scc0 L_dc_r
    s_mov_b32 s45, 0
L_dc_f:
    s_mov_b32 s35, 16
    s_cmp_eq_u32 s33, 4
    s_cbranch_scc1 L_db0
    s_mov_b32 s35, 1
    s_atomic_add s35, s[38:39], 64 glc
L_db0:
L_db:
    s_add_u32 m0, s65, 8192
    s_waitcnt vmcnt(19)
    buffer_load_dwordx4 v7, s[28:31], s66 offen offset:0 nt lds
    s_add_u32 s66, s66, 16384
    s_add_u32 m0, s65, 9216
    s_waitcnt vmcnt(19)
    buffer_load_dwordx4 v7, s[28:31], s66 offen offset:0 nt lds
    s_add_u32 s66, s66, 16384
    s_add_u32 m0, s65, 10240
    s_waitcnt vmcnt(19)
    buffer_load_dwordx4 v7, s[28:31], s66 offen offset:0 nt lds
    s_add_u32 s66, s66, 16384
    s_add_u32 m0, s65, 11264
    v_add_u32 v10, -16, v24
    s_waitcnt vmcnt(19)
    buffer_load_dwordx4 v7, s[28:31], s66 offen offset:0 nt lds
    ds_max_i32 v8, v10 offset:0
    s_add_u32 s66, s66, 16384
    v_add_u32 v24, 4, v24
    s_add_u32 s65, s65, 4096
    s_and_b32 s65, s65, 0x1ffff
    s_sub_u32 s67, s67, 1
    s_cmp_lg_u32 s67, 0
    s_cbranch_scc1 L_db
    s_branch L_dr
L_dend:
    v_mov_b32 v16, 0x100
    ds_write_b32 v22, v16 offset:0
    ds_write_b32 v22, v16 offset:4
    ds_write_b32 v22, v16 offset:8
    ds_write_b32 v22, v16 offset:12
    s_sub_u32 s48, s69, 16
    v_mov_b32 v10, s48
    s_waitcnt vmcnt(16)
    ds_max_i32 v8, v10 offset:0
    s_sub_u32 s48, s69, 12
    v_mov_b32 v10, s48
    s_waitcnt vmcnt(12)
    ds_max_i32 v8, v10 offset:0
    s_sub_u32 s48, s69, 8
    v_mov_b32 v10, s48
    s_waitcnt vmcnt(8)
    ds_max_i32 v8, v10 offset:0
    s_sub_u32 s48, s69, 4
    v_mov_b32 v10, s48
    s_waitcnt vmcnt(4)
    ds_max_i32 v8, v10 offset:0
    s_sub_u32 s48, s69, 0
    v_mov_b32 v10, s48
    s_waitcnt vmcnt(0)
    ds_max_i32 v8, v10 offset:0
    ds_write_b32 v9, v10 offset:312
    s_waitcnt lgkmcnt(0)
    s_branch L_fin
L_notloader:
    s_sub_u32 s44, s3, 1
    v_lshlrev_b32 v25, 5, v1
    v_lshlrev_b32 v26, 3, v1
    s_bfe_u32 s48, s2, 0x20004
    s_lshl_b32 s48, s48, 9
    s_waitcnt lgkmcnt(0)
    s_mov_b64 s[28:29], s[4:5]
    s_mov_b32 s30, 2048
    s_mov_b32 s31, 0x20000
    s_mov_b64 s[32:33], s[26:27]
    s_mov_b32 s34, 2228224
    s_mov_b32 s35, 0x20000
    s_mov_b32 s62, 786432
    s_cmp_lg_u32 s44, 0
    s_cbranch_scc1 L_nox
    buffer_load_dwordx4 v[104:107], v25, s[28:31], 0 offen
    buffer_load_dwordx4 v[108:111], v25, s[28:31], 0 offen offset:16
    buffer_load_dwordx2 v[96:97], v26, s[28:31], s48 offen
    s_and_b32 s48, s2, 7
    s_cbranch_scc1 L_nox2
    s_lshl_b32 s48, s2, 4
    s_add_u32 s48, s48, 720896
    s_mov_b32 exec_hi, 0
    buffer_store_dword v9, v8, s[32:35], s48 offen sc1
    s_mov_b64 exec, -1
    s_branch L_nox2
L_nox:
    s_getpc_b64 s[48:49]
L_pc:
    s_sub_u32 s48, s48, L_pc-parallel_sum__gqa_block_cached__swiglu_ffn__decode_kernel
    s_subb_u32 s49, s49, 0
    v_add_u32 v25, -128, v0
    v_lshlrev_b32 v25, 6, v25
    v_min_u32 v26, L_end-parallel_sum__gqa_block_cached__swiglu_ffn__decode_kernel, v25
    global_load_dword v96, v26, s[48:49]
L_nox2:
    buffer_load_dword v112, v9, s[32:35], s62 offen sc1
    v_mov_b32 v11, 1
    s_movk_i32 s43, 0x3ff
    v_and_b32 v25, 1, v1
    v_cmp_eq_u32 vcc, 1, v25
    v_mov_b32 v25, 0xffff
    v_mov_b32 v26, 0xffff0000
    v_cndmask_b32 v25, v25, v26, vcc
    v_lshrrev_b32 v26, 1, v13
    v_cmp_eq_u32 vcc, 0, v26
    s_nop 1
    v_cndmask_b32 v2, 0, v25, vcc
    v_cmp_eq_u32 vcc, 1, v26
    s_nop 1
    v_cndmask_b32 v3, 0, v25, vcc
    v_cmp_eq_u32 vcc, 2, v26
    s_nop 1
    v_cndmask_b32 v4, 0, v25, vcc
    v_cmp_eq_u32 vcc, 3, v26
    s_nop 1
    v_cndmask_b32 v5, 0, v25, vcc
    v_and_b32 v25, 1, v23
    v_lshlrev_b32 v25, 4, v25
    v_lshl_add_u32 v14, v13, 5, v25
    v_lshrrev_b32 v15, 5, v1
    v_lshl_add_u32 v14, v15, 8, v14
    v_and_b32 v24, 1, v23
    v_lshrrev_b32 v25, 1, v23
    v_lshl_or_b32 v24, v24, 1, v25
    v_lshlrev_b32 v24, 1, v24
    v_lshlrev_b32 v21, 4, v1
    v_and_b32 v22, 15, v1
    v_add_u32 v16, 8192, v21
    s_mov_b64 s[36:37], s[22:23]
    s_mov_b32 s38, 2048
    s_mov_b32 s39, 0x20000
    v_lshlrev_b32 v29, 10, v1
    v_mov_b32 v28, 0
    v_lshlrev_b32 v121, 6, v14
    v_lshlrev_b32 v122, 5, v14
    s_mov_b32 s50, 0x3db504f3
    s_mov_b32 s51, 0x3fb8aa3b
    s_mov_b32 s52, 0x05040100
    s_mov_b32 s53, 0x07060302
    s_mov_b32 s54, 0x00ff00ff
    s_mov_b32 s55, 0xff00ff00
    s_cmp_eq_u32 s3, 5
    s_cbranch_scc1 L_mgr
    s_cmp_gt_u32 s3, 5
    s_cbranch_scc1 L_bw
    s_lshl_b32 s48, s44, 12
    v_add_u32 v6, s48, v16
    s_lshl_b32 s48, s44, 2
    v_mov_b32 v18, s48
    s_mul_i32 s63, s44, 4096
    s_add_u32 s63, s63, 139264
    v_lshlrev_b32 v17, 3, v13
    v_lshl_add_u32 v17, v23, 6, v17
    v_add_u32 v17, s63, v17
    v_mov_b32 v28, v17
    s_waitcnt vmcnt(0)
    v_add_u32 v15, 1, v112
    s_nop 0
    v_readfirstlane_b32 s41, v15
    s_and_b32 s40, s41, 3
    s_and_b32 s41, s41, 0x3ff
    s_cmp_lg_u32 s44, 0
    s_cbranch_scc1 L_kphase
    v_lshlrev_b32 v76, 16, v104
    v_and_b32 v77, 0xffff0000, v104
    v_lshlrev_b32 v78, 16, v105
    v_and_b32 v79, 0xffff0000, v105
    v_lshlrev_b32 v80, 16, v106
    v_and_b32 v81, 0xffff0000, v106
    v_lshlrev_b32 v82, 16, v107
    v_and_b32 v83, 0xffff0000, v107
    v_lshlrev_b32 v84, 16, v108
    v_and_b32 v85, 0xffff0000, v108
    v_lshlrev_b32 v86, 16, v109
    v_and_b32 v87, 0xffff0000, v109
    v_lshlrev_b32 v88, 16, v110
    v_and_b32 v89, 0xffff0000, v110
    v_lshlrev_b32 v90, 16, v111
    v_and_b32 v91, 0xffff0000, v111
    v_add_f32 v104, v76, v77
    v_add_f32 v105, v78, v79
    v_add_f32 v106, v80, v81
    v_add_f32 v107, v82, v83
    v_add_f32 v108, v84, v85
    v_add_f32 v109, v86, v87
    v_add_f32 v110, v88, v89
    v_add_f32 v111, v90, v91
    v_add_f32 v104, v104, v108
    v_add_f32 v105, v105, v109
    v_add_f32 v106, v106, v110
    v_add_f32 v107, v107, v111
    v_add_f32 v104, v104, v105
    v_add_f32 v106, v106, v107
    v_add_f32 v92, v104, v106
    s_nop 1
    v_add_f32_dpp v92, v92, v92 row_ror:8 row_mask:0xf bank_mask:0xf
    s_nop 1
    v_add_f32_dpp v92, v92, v92 row_ror:4 row_mask:0xf bank_mask:0xf
    s_nop 1
    v_add_f32_dpp v92, v92, v92 row_ror:2 row_mask:0xf bank_mask:0xf
    s_nop 1
    v_add_f32_dpp v92, v92, v92 row_ror:1 row_mask:0xf bank_mask:0xf
    v_mov_b32 v93, v92
    s_nop 1
    v_permlane32_swap_b32 v92, v93
    v_add_f32 v92, v92, v93
    v_mov_b32 v93, v92
    s_nop 1
    v_permlane16_swap_b32 v92, v93
    v_add_f32 v92, v92, v93
    v_mul_f32 v92, 0x3a800000, v92
    v_sub_f32 v76, v76, v92
    v_sub_f32 v77, v77, v92
    v_sub_f32 v78, v78, v92
    v_sub_f32 v79, v79, v92
    v_sub_f32 v80, v80, v92
    v_sub_f32 v81, v81, v92
    v_sub_f32 v82, v82, v92
    v_sub_f32 v83, v83, v92
    v_sub_f32 v84, v84, v92
    v_sub_f32 v85, v85, v92
    v_sub_f32 v86, v86, v92
    v_sub_f32 v87, v87, v92
    v_sub_f32 v88, v88, v92
    v_sub_f32 v89, v89, v92
    v_sub_f32 v90, v90, v92
    v_sub_f32 v91, v91, v92
    v_mul_f32 v104, v76, v76
    v_mul_f32 v105, v77, v77
    v_mul_f32 v106, v78, v78
    v_mul_f32 v107, v79, v79
    v_fmac_f32 v104, v80, v80
    v_fmac_f32 v105, v81, v81
    v_fmac_f32 v106, v82, v82
    v_fmac_f32 v107, v83, v83
    v_fmac_f32 v104, v84, v84
    v_fmac_f32 v105, v85, v85
    v_fmac_f32 v106, v86, v86
    v_fmac_f32 v107, v87, v87
    v_fmac_f32 v104, v88, v88
    v_fmac_f32 v105, v89, v89
    v_fmac_f32 v106, v90, v90
    v_fmac_f32 v107, v91, v91
    v_add_f32 v104, v104, v105
    v_add_f32 v106, v106, v107
    v_add_f32 v94, v104, v106
    s_nop 1
    v_add_f32_dpp v94, v94, v94 row_ror:8 row_mask:0xf bank_mask:0xf
    s_nop 1
    v_add_f32_dpp v94, v94, v94 row_ror:4 row_mask:0xf bank_mask:0xf
    s_nop 1
    v_add_f32_dpp v94, v94, v94 row_ror:2 row_mask:0xf bank_mask:0xf
    s_nop 1
    v_add_f32_dpp v94, v94, v94 row_ror:1 row_mask:0xf bank_mask:0xf
    v_mov_b32 v93, v94
    s_nop 1
    v_permlane32_swap_b32 v94, v93
    v_add_f32 v94, v94, v93
    v_mov_b32 v93, v94
    s_nop 1
    v_permlane16_swap_b32 v94, v93
    v_add_f32 v94, v94, v93
    v_mul_f32 v94, 0x3a800000, v94
    v_cvt_pk_bf16_f32 v94, v94, v92
    v_and_b32 v92, 0xffff0000, v94
    v_lshlrev_b32 v94, 16, v94
    v_add_f32 v94, 0x3727c5ac, v94
    v_cvt_pk_bf16_f32 v94, v94, v94
    v_and_b32 v94, 0xffff0000, v94
    v_sqrt_f32 v94, v94
    s_nop 0
    v_cvt_pk_bf16_f32 v94, v94, v94
    v_and_b32 v94, 0xffff0000, v94
    v_rcp_f32 v95, v94
    v_lshlrev_b32 v100, 16, v96
    v_and_b32 v101, 0xffff0000, v96
    v_lshlrev_b32 v102, 16, v97
    v_and_b32 v103, 0xffff0000, v97
    v_sub_f32 v100, v100, v92
    v_sub_f32 v101, v101, v92
    v_sub_f32 v102, v102, v92
    v_sub_f32 v103, v103, v92
    v_cvt_pk_bf16_f32 v100, v100, v100
    v_cvt_pk_bf16_f32 v101, v101, v101
    v_cvt_pk_bf16_f32 v102, v102, v102
    v_cvt_pk_bf16_f32 v103, v103, v103
    v_and_b32 v100, 0xffff0000, v100
    v_and_b32 v101, 0xffff0000, v101
    v_and_b32 v102, 0xffff0000, v102
    v_and_b32 v103, 0xffff0000, v103
    v_mul_f32 v76, v100, v95
    v_mul_f32 v77, v101, v95
    v_mul_f32 v78, v102, v95
    v_mul_f32 v79, v103, v95
    v_fma_f32 v82, -v76, v94, v100
    v_fma_f32 v83, -v77, v94, v101
    v_fma_f32 v84, -v78, v94, v102
    v_fma_f32 v85, -v79, v94, v103
    v_fma_f32 v76, v82, v95, v76
    v_fma_f32 v77, v83, v95, v77
    v_fma_f32 v78, v84, v95, v78
    v_fma_f32 v79, v85, v95, v79
    v_cvt_pk_bf16_f32 v100, v76, v76
    v_cvt_pk_bf16_f32 v101, v77, v77
    v_cvt_pk_bf16_f32 v102, v78, v78
    v_cvt_pk_bf16_f32 v103, v79, v79
    ds_write_b128 v21, v[100:103] offset:5376
    v_mov_b32 v26, v16
    s_mov_b32 s56, 8
    s_lshr_b32 s57, s2, 4
    s_lshl_b32 s57, s57, 12
    s_and_b32 s48, s2, 15
    s_lshl_b32 s48, s48, 8
    s_add_u32 s57, s57, s48
    v_lshlrev_b32 v25, 7, v12
    s_mov_b32 s49, 4
    v_mov_b32 v48, 0
    v_mov_b32 v49, 0
    v_mov_b32 v50, 0
    v_mov_b32 v51, 0
L_gv:
    ds_read_b128 v[64:67], v25 offset:5376
    ds_read_b128 v[68:71], v25 offset:5392
    s_waitcnt lgkmcnt(0)
    v_and_b32 v160, v64, v2
    v_and_b32 v161, v64, v3
    v_and_b32 v162, v64, v4
    v_and_b32 v163, v64, v5
    v_and_b32 v164, v65, v2
    v_and_b32 v165, v65, v3
    v_and_b32 v166, v65, v4
    v_and_b32 v167, v65, v5
    v_and_b32 v168, v66, v2
    v_and_b32 v169, v66, v3
    v_and_b32 v170, v66, v4
    v_and_b32 v171, v66, v5
    v_and_b32 v172, v67, v2
    v_and_b32 v173, v67, v3
    v_and_b32 v174, v67, v4
    v_and_b32 v175, v67, v5
    v_and_b32 v176, v68, v2
    v_and_b32 v177, v68, v3
    v_and_b32 v178, v68, v4
    v_and_b32 v179, v68, v5
    v_and_b32 v180, v69, v2
    v_and_b32 v181, v69, v3
    v_and_b32 v182, v69, v4
    v_and_b32 v183, v69, v5
    v_and_b32 v184, v70, v2
    v_and_b32 v185, v70, v3
    v_and_b32 v186, v70, v4
    v_and_b32 v187, v70, v5
    v_and_b32 v188, v71, v2
    v_and_b32 v189, v71, v3
    v_and_b32 v190, v71, v4
    v_and_b32 v191, v71, v5
L_w1:
    ds_read_b32 v10, v8 offset:0
    s_waitcnt lgkmcnt(0)
    v_cmp_gt_i32 vcc, s56, v10
    s_cbranch_vccz L_w1d
    s_sub_u32 s45, s45, 1
    s_cbranch_scc1 L_w1x
    s_sleep 1
    s_branch L_w1
L_w1x:
    s_mov_b32 s45, 0
L_w1d:
    ds_read_b128 v[128:131], v26 offset:0
    ds_read_b128 v[132:135], v26 offset:1024
    ds_read_b128 v[136:139], v26 offset:2048
    ds_read_b128 v[140:143], v26 offset:3072
    ds_read_b128 v[144:147], v26 offset:4096
    ds_read_b128 v[148:151], v26 offset:5120
    ds_read_b128 v[152:155], v26 offset:6144
    ds_read_b128 v[156:159], v26 offset:7168
    v_add_u32 v25, 32, v25
    v_add_u32 v26, 0x2000, v26
    s_add_u32 s56, s56, 8
    s_waitcnt lgkmcnt(0)
    v_mfma_f32_16x16x32_bf16 v[48:51], v[160:163], v[128:131], v[48:51]
    v_mfma_f32_16x16x32_bf16 v[48:51], v[164:167], v[132:135], v[48:51]
    v_mfma_f32_16x16x32_bf16 v[48:51], v[168:171], v[136:139], v[48:51]
    v_mfma_f32_16x16x32_bf16 v[48:51], v[172:175], v[140:143], v[48:51]
    v_mfma_f32_16x16x32_bf16 v[48:51], v[176:179], v[144:147], v[48:51]
    v_mfma_f32_16x16x32_bf16 v[48:51], v[180:183], v[148:151], v[48:51]
    v_mfma_f32_16x16x32_bf16 v[48:51], v[184:187], v[152:155], v[48:51]
    v_mfma_f32_16x16x32_bf16 v[48:51], v[188:191], v[156:159], v[48:51]
    s_sub_u32 s49, s49, 1
    s_cmp_lg_u32 s49, 0
    s_cbranch_scc1 L_gv
    s_nop 4
    v_mov_b32_dpp v52, v48 row_ror:8 row_mask:0xf bank_mask:0xf
    v_mov_b32_dpp v53, v49 row_ror:8 row_mask:0xf bank_mask:0xf
    v_mov_b32_dpp v54, v50 row_ror:8 row_mask:0xf bank_mask:0xf
    v_mov_b32_dpp v55, v51 row_ror:8 row_mask:0xf bank_mask:0xf
    v_permlane32_swap_b32 v52, v56
    v_permlane32_swap_b32 v53, v57
    v_permlane32_swap_b32 v54, v58
    v_permlane32_swap_b32 v55, v59
    v_add_f32 v48, v48, v56
    v_add_f32 v49, v49, v57
    v_add_f32 v50, v50, v58
    v_add_f32 v51, v51, v59
    v_bfi_b32 v48, 3, v15, v48
    v_bfi_b32 v49, 3, v15, v49
    v_bfi_b32 v50, 3, v15, v50
    v_bfi_b32 v51, 3, v15, v51
    s_mov_b32 exec_lo, s54
    s_mov_b32 exec_hi, 0
    buffer_store_dwordx4 v[48:51], v14, s[32:35], s57 offen sc1
    s_mov_b64 exec, -1
L_kphase:
    s_lshl_b32 s56, s44, 2
    s_add_u32 s56, s56, 32
    v_mov_b32 v19, s56
    s_add_u32 s56, s56, 4
    s_mov_b32 s57, 32768
    ds_write_b32 v18, v19 offset:256
    v_add_u32 v7, s57, v6
    s_mov_b32 s64, 0x00ff00ff
    s_mov_b32 s65, 0x00ff00ff
L_w2:
    ds_read_b32 v10, v8 offset:0
    s_waitcnt lgkmcnt(0)
    v_cmp_gt_i32 vcc, s56, v10
    s_cbranch_vccz L_w2d
    s_sub_u32 s45, s45, 1
    s_cbranch_scc1 L_w2x
    s_sleep 1
    s_branch L_w2
L_w2x:
    s_mov_b32 s45, 0
L_w2d:
    ds_read_b128 v[128:131], v7 offset:0
    ds_read_b128 v[132:135], v7 offset:1024
    ds_read_b128 v[136:139], v7 offset:2048
    ds_read_b128 v[140:143], v7 offset:3072
    s_add_u32 s56, s56, 16
    s_add_u32 s57, s57, 16384
    s_and_b32 s57, s57, 0x1ffff
    v_add_u32 v19, 16, v19
    s_waitcnt lgkmcnt(0)
    ds_write_b32 v18, v19 offset:256
    v_add_u32 v7, s57, v6
L_w3:
    ds_read_b32 v10, v8 offset:0
    s_waitcnt lgkmcnt(0)
    v_cmp_gt_i32 vcc, s56, v10
    s_cbranch_vccz L_w3d
    s_sub_u32 s45, s45, 1
    s_cbranch_scc1 L_w3x
    s_sleep 1
    s_branch L_w3
L_w3x:
    s_mov_b32 s45, 0
L_w3d:
    ds_read_b128 v[144:147], v7 offset:0
    ds_read_b128 v[148:151], v7 offset:1024
    ds_read_b128 v[152:155], v7 offset:2048
    ds_read_b128 v[156:159], v7 offset:3072
    s_add_u32 s56, s56, 16
    s_add_u32 s57, s57, 16384
    s_and_b32 s57, s57, 0x1ffff
    v_add_u32 v19, 16, v19
    s_waitcnt lgkmcnt(0)
    ds_write_b32 v18, v19 offset:256
    v_add_u32 v7, s57, v6
L_w4:
    ds_read_b32 v10, v8 offset:0
    s_waitcnt lgkmcnt(0)
    v_cmp_gt_i32 vcc, s56, v10
    s_cbranch_vccz L_w4d
    s_sub_u32 s45, s45, 1
    s_cbranch_scc1 L_w4x
    s_sleep 1
    s_branch L_w4
L_w4x:
    s_mov_b32 s45, 0
L_w4d:
    ds_read_b128 v[160:163], v7 offset:0
    ds_read_b128 v[164:167], v7 offset:1024
    ds_read_b128 v[168:171], v7 offset:2048
    ds_read_b128 v[172:175], v7 offset:3072
    s_add_u32 s56, s56, 16
    s_add_u32 s57, s57, 16384
    s_and_b32 s57, s57, 0x1ffff
    v_add_u32 v19, 16, v19
    s_waitcnt lgkmcnt(0)
    ds_write_b32 v18, v19 offset:256
    v_add_u32 v7, s57, v6
L_w5:
    ds_read_b32 v10, v8 offset:0
    s_waitcnt lgkmcnt(0)
    v_cmp_gt_i32 vcc, s56, v10
    s_cbranch_vccz L_w5d
    s_sub_u32 s45, s45, 1
    s_cbranch_scc1 L_w5x
    s_sleep 1
    s_branch L_w5
L_w5x:
    s_mov_b32 s45, 0
L_w5d:
    ds_read_b128 v[176:179], v7 offset:0
    ds_read_b128 v[180:183], v7 offset:1024
    ds_read_b128 v[184:187], v7 offset:2048
    ds_read_b128 v[188:191], v7 offset:3072
    s_add_u32 s56, s56, 16
    s_add_u32 s57, s57, 16384
    s_and_b32 s57, s57, 0x1ffff
    v_add_u32 v19, 16, v19
    s_waitcnt lgkmcnt(0)
    ds_write_b32 v18, v19 offset:256
    v_add_u32 v7, s57, v6
L_w6:
    ds_read_b32 v10, v8 offset:0
    s_waitcnt lgkmcnt(0)
    v_cmp_gt_i32 vcc, s56, v10
    s_cbranch_vccz L_w6d
    s_sub_u32 s45, s45, 1
    s_cbranch_scc1 L_w6x
    s_sleep 1
    s_branch L_w6
L_w6x:
    s_mov_b32 s45, 0
L_w6d:
    ds_read_b128 v[192:195], v7 offset:0
    ds_read_b128 v[196:199], v7 offset:1024
    ds_read_b128 v[200:203], v7 offset:2048
    ds_read_b128 v[204:207], v7 offset:3072
    s_add_u32 s56, s56, 16
    s_add_u32 s57, s57, 16384
    s_and_b32 s57, s57, 0x1ffff
    v_add_u32 v19, 16, v19
    s_waitcnt lgkmcnt(0)
    ds_write_b32 v18, v19 offset:256
    v_add_u32 v7, s57, v6
L_w7:
    ds_read_b32 v10, v8 offset:0
    s_waitcnt lgkmcnt(0)
    v_cmp_gt_i32 vcc, s56, v10
    s_cbranch_vccz L_w7d
    s_sub_u32 s45, s45, 1
    s_cbranch_scc1 L_w7x
    s_sleep 1
    s_branch L_w7
L_w7x:
    s_mov_b32 s45, 0
L_w7d:
    ds_read_b128 v[208:211], v7 offset:0
    ds_read_b128 v[212:215], v7 offset:1024
    ds_read_b128 v[216:219], v7 offset:2048
    ds_read_b128 v[220:223], v7 offset:3072
    s_add_u32 s56, s56, 16
    s_add_u32 s57, s57, 16384
    s_and_b32 s57, s57, 0x1ffff
    v_add_u32 v19, 16, v19
    s_waitcnt lgkmcnt(0)
    ds_write_b32 v18, v19 offset:256
    v_add_u32 v7, s57, v6
L_w8:
    ds_read_b32 v10, v8 offset:0
    s_waitcnt lgkmcnt(0)
    v_cmp_gt_i32 vcc, s56, v10
    s_cbranch_vccz L_w8d
    s_sub_u32 s45, s45, 1
    s_cbranch_scc1 L_w8x
    s_sleep 1
    s_branch L_w8
L_w8x:
    s_mov_b32 s45, 0
L_w8d:
    ds_read_b128 v[224:227], v7 offset:0
    ds_read_b128 v[228:231], v7 offset:1024
    ds_read_b128 v[232:235], v7 offset:2048
    ds_read_b128 v[236:239], v7 offset:3072
    s_add_u32 s56, s56, 16
    s_add_u32 s57, s57, 16384
    s_and_b32 s57, s57, 0x1ffff
    v_add_u32 v19, 16, v19
    s_waitcnt lgkmcnt(0)
    ds_write_b32 v18, v19 offset:256
    v_add_u32 v7, s57, v6
L_w9:
    ds_read_b32 v10, v8 offset:0
    s_waitcnt lgkmcnt(0)
    v_cmp_gt_i32 vcc, s56, v10
    s_cbranch_vccz L_w9d
    s_sub_u32 s45, s45, 1
    s_cbranch_scc1 L_w9x
    s_sleep 1
    s_branch L_w9
L_w9x:
    s_mov_b32 s45, 0
L_w9d:
    ds_read_b128 v[240:243], v7 offset:0
    ds_read_b128 v[244:247], v7 offset:1024
    ds_read_b128 v[248:251], v7 offset:2048
    ds_read_b128 v[252:255], v7 offset:3072
    s_add_u32 s56, s56, 16
    s_add_u32 s57, s57, 16384
    s_and_b32 s57, s57, 0x1ffff
    v_add_u32 v19, 16, v19
    s_waitcnt lgkmcnt(0)
    ds_write_b32 v18, v19 offset:256
    v_add_u32 v7, s57, v6
    v_lshlrev_b32 v25, 8, v13
    v_lshl_add_u32 v25, v23, 4, v25
    v_and_b32 v26, 1, v12
    v_lshl_add_u32 v25, v26, 6, v25
    v_mov_b32 v27, 0xff800000
    v_mov_b32 v32, 0
    v_mov_b32 v33, 0
    v_mov_b32 v34, 0
    v_mov_b32 v35, 0
    v_mov_b32 v36, 0
    v_mov_b32 v37, 0
    v_mov_b32 v38, 0
    v_mov_b32 v39, 0
    v_mov_b32 v40, 0
    v_mov_b32 v41, 0
    v_mov_b32 v42, 0
    v_mov_b32 v43, 0
    v_mov_b32 v44, 0
    v_mov_b32 v45, 0
    v_mov_b32 v46, 0
    v_mov_b32 v47, 0
    v_mov_b32 v48, 0
    v_mov_b32 v49, 0
    v_mov_b32 v50, 0
    v_mov_b32 v51, 0
    v_mov_b32 v52, 0
    v_mov_b32 v53, 0
    v_mov_b32 v54, 0
    v_mov_b32 v55, 0
    v_mov_b32 v56, 0
    v_mov_b32 v57, 0
    v_mov_b32 v58, 0
    v_mov_b32 v59, 0
    v_mov_b32 v60, 0
    v_mov_b32 v61, 0
    v_mov_b32 v62, 0
    v_mov_b32 v63, 0
    v_lshlrev_b32 v112, 4, v22
    v_lshl_add_u32 v112, v23, 11, v112
    v_add_u32 v112, s63, v112
    s_lshl_b32 s48, s44, 10
    v_add_u32 v113, s48, v21
    v_add_u32 v113, 139264, v113
    s_lshl_b32 s66, s47, 18
    s_lshl_b32 s48, s46, 8
    s_add_u32 s66, s66, s48
    s_lshl_b32 s48, s44, 16
    s_add_u32 s66, s66, s48
    s_add_u32 s66, s66, 1179648
    v_lshlrev_b32 v114, 4, v22
    v_lshl_add_u32 v114, v23, 14, v114
    s_lshl_b32 s67, s46, 14
    s_lshl_b32 s48, s44, 12
    s_add_u32 s67, s67, s48
    s_add_u32 s67, s67, 1179648
    s_lshl_b32 s68, s2, 10
    s_lshl_b32 s48, s44, 8
    s_add_u32 s68, s68, s48
    s_add_u32 s68, s68, 131072
    v_lshlrev_b32 v115, 6, v22
    v_lshl_add_u32 v115, v24, 3, v115
    v_add_u32 v115, v115, v18
    v_lshlrev_b32 v116, 4, v12
    s_lshl_b32 s48, s44, 8
    v_lshl_add_u32 v117, v23, 4, s48
L_w10:
    ds_read_b32 v10, v9 offset:280
    s_waitcnt lgkmcnt(0)
    v_cmp_gt_i32 vcc, 1, v10
    s_cbranch_vccz L_w10d
    s_sub_u32 s45, s45, 1
    s_cbranch_scc1 L_w10x
    s_sleep 1
    s_branch L_w10
L_w10x:
    s_mov_b32 s45, 0
L_w10d:
    ds_read_b128 v[64:67], v25 offset:3328
    ds_read_b128 v[68:71], v25 offset:3456
    s_waitcnt lgkmcnt(0)
    v_mfma_f32_16x16x32_bf16 v[72:75], v[128:131], v[64:67], 0
    v_mfma_f32_16x16x32_bf16 v[72:75], v[132:135], v[68:71], v[72:75]
    v_mfma_f32_16x16x32_bf16 v[76:79], v[136:139], v[64:67], 0
    v_mfma_f32_16x16x32_bf16 v[76:79], v[140:143], v[68:71], v[76:79]
    s_nop 5
    v_add_f32_dpp v80, v73, v72 row_ror:8 row_mask:0xf bank_mask:0xf
    v_add_f32_dpp v81, v75, v74 row_ror:8 row_mask:0xf bank_mask:0xf
    v_add_f32_dpp v82, v77, v76 row_ror:8 row_mask:0xf bank_mask:0xf
    v_add_f32_dpp v83, v79, v78 row_ror:8 row_mask:0xf bank_mask:0xf
    v_max3_f32 v27, v27, v80, v81
    v_cvt_pk_bf16_f32 v84, v80, v81
    v_max3_f32 v27, v27, v82, v83
    v_cvt_pk_bf16_f32 v85, v82, v83
    v_lshlrev_b32 v80, 16, v84
    v_and_b32 v81, 0xffff0000, v84
    v_lshlrev_b32 v82, 16, v85
    v_and_b32 v83, 0xffff0000, v85
    v_mul_f32 v80, s50, v80
    v_mul_f32 v81, s50, v81
    v_mul_f32 v82, s50, v82
    v_mul_f32 v83, s50, v83
    v_cvt_pk_bf16_f32 v84, v80, v81
    v_cvt_pk_bf16_f32 v85, v82, v83
    s_mov_b64 exec, s[64:65]
    ds_write_b64 v17, v[84:85]
    s_mov_b64 exec, -1
    v_add_u32 v17, 0x100, v17
    v_mfma_f32_16x16x32_bf16 v[72:75], v[144:147], v[64:67], 0
    v_mfma_f32_16x16x32_bf16 v[72:75], v[148:151], v[68:71], v[72:75]
    v_mfma_f32_16x16x32_bf16 v[76:79], v[152:155], v[64:67], 0
    v_mfma_f32_16x16x32_bf16 v[76:79], v[156:159], v[68:71], v[76:79]
    s_nop 5
    v_add_f32_dpp v80, v73, v72 row_ror:8 row_mask:0xf bank_mask:0xf
    v_add_f32_dpp v81, v75, v74 row_ror:8 row_mask:0xf bank_mask:0xf
    v_add_f32_dpp v82, v77, v76 row_ror:8 row_mask:0xf bank_mask:0xf
    v_add_f32_dpp v83, v79, v78 row_ror:8 row_mask:0xf bank_mask:0xf
    v_max3_f32 v27, v27, v80, v81
    v_cvt_pk_bf16_f32 v84, v80, v81
    v_max3_f32 v27, v27, v82, v83
    v_cvt_pk_bf16_f32 v85, v82, v83
    v_lshlrev_b32 v80, 16, v84
    v_and_b32 v81, 0xffff0000, v84
    v_lshlrev_b32 v82, 16, v85
    v_and_b32 v83, 0xffff0000, v85
    v_mul_f32 v80, s50, v80
    v_mul_f32 v81, s50, v81
    v_mul_f32 v82, s50, v82
    v_mul_f32 v83, s50, v83
    v_cvt_pk_bf16_f32 v84, v80, v81
    v_cvt_pk_bf16_f32 v85, v82, v83
    s_mov_b64 exec, s[64:65]
    ds_write_b64 v17, v[84:85]
    s_mov_b64 exec, -1
    v_add_u32 v17, 0x100, v17
    v_mfma_f32_16x16x32_bf16 v[72:75], v[160:163], v[64:67], 0
    v_mfma_f32_16x16x32_bf16 v[72:75], v[164:167], v[68:71], v[72:75]
    v_mfma_f32_16x16x32_bf16 v[76:79], v[168:171], v[64:67], 0
    v_mfma_f32_16x16x32_bf16 v[76:79], v[172:175], v[68:71], v[76:79]
    s_nop 5
    v_add_f32_dpp v80, v73, v72 row_ror:8 row_mask:0xf bank_mask:0xf
    v_add_f32_dpp v81, v75, v74 row_ror:8 row_mask:0xf bank_mask:0xf
    v_add_f32_dpp v82, v77, v76 row_ror:8 row_mask:0xf bank_mask:0xf
    v_add_f32_dpp v83, v79, v78 row_ror:8 row_mask:0xf bank_mask:0xf
    v_max3_f32 v27, v27, v80, v81
    v_cvt_pk_bf16_f32 v84, v80, v81
    v_max3_f32 v27, v27, v82, v83
    v_cvt_pk_bf16_f32 v85, v82, v83
    v_lshlrev_b32 v80, 16, v84
    v_and_b32 v81, 0xffff0000, v84
    v_lshlrev_b32 v82, 16, v85
    v_and_b32 v83, 0xffff0000, v85
    v_mul_f32 v80, s50, v80
    v_mul_f32 v81, s50, v81
    v_mul_f32 v82, s50, v82
    v_mul_f32 v83, s50, v83
    v_cvt_pk_bf16_f32 v84, v80, v81
    v_cvt_pk_bf16_f32 v85, v82, v83
    s_mov_b64 exec, s[64:65]
    ds_write_b64 v17, v[84:85]
    s_mov_b64 exec, -1
    v_add_u32 v17, 0x100, v17
    v_mfma_f32_16x16x32_bf16 v[72:75], v[176:179], v[64:67], 0
    v_mfma_f32_16x16x32_bf16 v[72:75], v[180:183], v[68:71], v[72:75]
    v_mfma_f32_16x16x32_bf16 v[76:79], v[184:187], v[64:67], 0
    v_mfma_f32_16x16x32_bf16 v[76:79], v[188:191], v[68:71], v[76:79]
    s_nop 5
    v_add_f32_dpp v80, v73, v72 row_ror:8 row_mask:0xf bank_mask:0xf
    v_add_f32_dpp v81, v75, v74 row_ror:8 row_mask:0xf bank_mask:0xf
    v_add_f32_dpp v82, v77, v76 row_ror:8 row_mask:0xf bank_mask:0xf
    v_add_f32_dpp v83, v79, v78 row_ror:8 row_mask:0xf bank_mask:0xf
    v_max3_f32 v27, v27, v80, v81
    v_cvt_pk_bf16_f32 v84, v80, v81
    v_max3_f32 v27, v27, v82, v83
    v_cvt_pk_bf16_f32 v85, v82, v83
    v_lshlrev_b32 v80, 16, v84
    v_and_b32 v81, 0xffff0000, v84
    v_lshlrev_b32 v82, 16, v85
    v_and_b32 v83, 0xffff0000, v85
    v_mul_f32 v80, s50, v80
    v_mul_f32 v81, s50, v81
    v_mul_f32 v82, s50, v82
    v_mul_f32 v83, s50, v83
    v_cvt_pk_bf16_f32 v84, v80, v81
    v_cvt_pk_bf16_f32 v85, v82, v83
    s_mov_b64 exec, s[64:65]
    ds_write_b64 v17, v[84:85]
    s_mov_b64 exec, -1
    v_add_u32 v17, 0x100, v17
    v_mfma_f32_16x16x32_bf16 v[72:75], v[192:195], v[64:67], 0
    v_mfma_f32_16x16x32_bf16 v[72:75], v[196:199], v[68:71], v[72:75]
    v_mfma_f32_16x16x32_bf16 v[76:79], v[200:203], v[64:67], 0
    v_mfma_f32_16x16x32_bf16 v[76:79], v[204:207], v[68:71], v[76:79]
    s_nop 5
    v_add_f32_dpp v80, v73, v72 row_ror:8 row_mask:0xf bank_mask:0xf
    v_add_f32_dpp v81, v75, v74 row_ror:8 row_mask:0xf bank_mask:0xf
    v_add_f32_dpp v82, v77, v76 row_ror:8 row_mask:0xf bank_mask:0xf
    v_add_f32_dpp v83, v79, v78 row_ror:8 row_mask:0xf bank_mask:0xf
    v_max3_f32 v27, v27, v80, v81
    v_cvt_pk_bf16_f32 v84, v80, v81
    v_max3_f32 v27, v27, v82, v83
    v_cvt_pk_bf16_f32 v85, v82, v83
    v_lshlrev_b32 v80, 16, v84
    v_and_b32 v81, 0xffff0000, v84
    v_lshlrev_b32 v82, 16, v85
    v_and_b32 v83, 0xffff0000, v85
    v_mul_f32 v80, s50, v80
    v_mul_f32 v81, s50, v81
    v_mul_f32 v82, s50, v82
    v_mul_f32 v83, s50, v83
    v_cvt_pk_bf16_f32 v84, v80, v81
    v_cvt_pk_bf16_f32 v85, v82, v83
    s_mov_b64 exec, s[64:65]
    ds_write_b64 v17, v[84:85]
    s_mov_b64 exec, -1
    v_add_u32 v17, 0x100, v17
    v_mfma_f32_16x16x32_bf16 v[72:75], v[208:211], v[64:67], 0
    v_mfma_f32_16x16x32_bf16 v[72:75], v[212:215], v[68:71], v[72:75]
    v_mfma_f32_16x16x32_bf16 v[76:79], v[216:219], v[64:67], 0
    v_mfma_f32_16x16x32_bf16 v[76:79], v[220:223], v[68:71], v[76:79]
    s_nop 5
    v_add_f32_dpp v80, v73, v72 row_ror:8 row_mask:0xf bank_mask:0xf
    v_add_f32_dpp v81, v75, v74 row_ror:8 row_mask:0xf bank_mask:0xf
    v_add_f32_dpp v82, v77, v76 row_ror:8 row_mask:0xf bank_mask:0xf
    v_add_f32_dpp v83, v79, v78 row_ror:8 row_mask:0xf bank_mask:0xf
    v_max3_f32 v27, v27, v80, v81
    v_cvt_pk_bf16_f32 v84, v80, v81
    v_max3_f32 v27, v27, v82, v83
    v_cvt_pk_bf16_f32 v85, v82, v83
    v_lshlrev_b32 v80, 16, v84
    v_and_b32 v81, 0xffff0000, v84
    v_lshlrev_b32 v82, 16, v85
    v_and_b32 v83, 0xffff0000, v85
    v_mul_f32 v80, s50, v80
    v_mul_f32 v81, s50, v81
    v_mul_f32 v82, s50, v82
    v_mul_f32 v83, s50, v83
    v_cvt_pk_bf16_f32 v84, v80, v81
    v_cvt_pk_bf16_f32 v85, v82, v83
    s_mov_b64 exec, s[64:65]
    ds_write_b64 v17, v[84:85]
    s_mov_b64 exec, -1
    v_add_u32 v17, 0x100, v17
    v_mfma_f32_16x16x32_bf16 v[72:75], v[224:227], v[64:67], 0
    v_mfma_f32_16x16x32_bf16 v[72:75], v[228:231], v[68:71], v[72:75]
    v_mfma_f32_16x16x32_bf16 v[76:79], v[232:235], v[64:67], 0
    v_mfma_f32_16x16x32_bf16 v[76:79], v[236:239], v[68:71], v[76:79]
    s_nop 5
    v_add_f32_dpp v80, v73, v72 row_ror:8 row_mask:0xf bank_mask:0xf
    v_add_f32_dpp v81, v75, v74 row_ror:8 row_mask:0xf bank_mask:0xf
    v_add_f32_dpp v82, v77, v76 row_ror:8 row_mask:0xf bank_mask:0xf
    v_add_f32_dpp v83, v79, v78 row_ror:8 row_mask:0xf bank_mask:0xf
    v_max3_f32 v27, v27, v80, v81
    v_cvt_pk_bf16_f32 v84, v80, v81
    v_max3_f32 v27, v27, v82, v83
    v_cvt_pk_bf16_f32 v85, v82, v83
    v_lshlrev_b32 v80, 16, v84
    v_and_b32 v81, 0xffff0000, v84
    v_lshlrev_b32 v82, 16, v85
    v_and_b32 v83, 0xffff0000, v85
    v_mul_f32 v80, s50, v80
    v_mul_f32 v81, s50, v81
    v_mul_f32 v82, s50, v82
    v_mul_f32 v83, s50, v83
    v_cvt_pk_bf16_f32 v84, v80, v81
    v_cvt_pk_bf16_f32 v85, v82, v83
    s_mov_b64 exec, s[64:65]
    ds_write_b64 v17, v[84:85]
    s_mov_b64 exec, -1
    v_add_u32 v17, 0x100, v17
    v_mfma_f32_16x16x32_bf16 v[72:75], v[240:243], v[64:67], 0
    v_mfma_f32_16x16x32_bf16 v[72:75], v[244:247], v[68:71], v[72:75]
    v_mfma_f32_16x16x32_bf16 v[76:79], v[248:251], v[64:67], 0
    v_mfma_f32_16x16x32_bf16 v[76:79], v[252:255], v[68:71], v[76:79]
    s_nop 5
    v_add_f32_dpp v80, v73, v72 row_ror:8 row_mask:0xf bank_mask:0xf
    v_add_f32_dpp v81, v75, v74 row_ror:8 row_mask:0xf bank_mask:0xf
    v_add_f32_dpp v82, v77, v76 row_ror:8 row_mask:0xf bank_mask:0xf
    v_add_f32_dpp v83, v79, v78 row_ror:8 row_mask:0xf bank_mask:0xf
    v_max3_f32 v27, v27, v80, v81
    v_cvt_pk_bf16_f32 v84, v80, v81
    v_max3_f32 v27, v27, v82, v83
    v_cvt_pk_bf16_f32 v85, v82, v83
    v_lshlrev_b32 v80, 16, v84
    v_and_b32 v81, 0xffff0000, v84
    v_lshlrev_b32 v82, 16, v85
    v_and_b32 v83, 0xffff0000, v85
    v_mul_f32 v80, s50, v80
    v_mul_f32 v81, s50, v81
    v_mul_f32 v82, s50, v82
    v_mul_f32 v83, s50, v83
    v_cvt_pk_bf16_f32 v84, v80, v81
    v_cvt_pk_bf16_f32 v85, v82, v83
    s_mov_b64 exec, s[64:65]
    ds_write_b64 v17, v[84:85]
    s_mov_b64 exec, -1
    v_add_u32 v17, 0x100, v17
    s_mov_b32 s58, 8
L_ck:
L_w11:
    ds_read_b32 v10, v8 offset:0
    s_waitcnt lgkmcnt(0)
    v_cmp_gt_i32 vcc, s56, v10
    s_cbranch_vccz L_w11d
    s_sub_u32 s45, s45, 1
    s_cbranch_scc1 L_w11x
    s_sleep 1
    s_branch L_w11
L_w11x:
    s_mov_b32 s45, 0
L_w11d:
    ds_read_b128 v[128:131], v7 offset:0
    ds_read_b128 v[132:135], v7 offset:1024
    ds_read_b128 v[136:139], v7 offset:2048
    ds_read_b128 v[140:143], v7 offset:3072
    s_add_u32 s56, s56, 16
    s_add_u32 s57, s57, 16384
    s_and_b32 s57, s57, 0x1ffff
    v_add_u32 v19, 16, v19
    s_waitcnt lgkmcnt(0)
    ds_write_b32 v18, v19 offset:256
    v_add_u32 v7, s57, v6
    v_mfma_f32_16x16x32_bf16 v[72:75], v[128:131], v[64:67], 0
    v_mfma_f32_16x16x32_bf16 v[72:75], v[132:135], v[68:71], v[72:75]
    v_mfma_f32_16x16x32_bf16 v[76:79], v[136:139], v[64:67], 0
    v_mfma_f32_16x16x32_bf16 v[76:79], v[140:143], v[68:71], v[76:79]
    s_nop 5
    v_add_f32_dpp v80, v73, v72 row_ror:8 row_mask:0xf bank_mask:0xf
    v_add_f32_dpp v81, v75, v74 row_ror:8 row_mask:0xf bank_mask:0xf
    v_add_f32_dpp v82, v77, v76 row_ror:8 row_mask:0xf bank_mask:0xf
    v_add_f32_dpp v83, v79, v78 row_ror:8 row_mask:0xf bank_mask:0xf
    v_max3_f32 v27, v27, v80, v81
    v_cvt_pk_bf16_f32 v84, v80, v81
    v_max3_f32 v27, v27, v82, v83
    v_cvt_pk_bf16_f32 v85, v82, v83
    v_lshlrev_b32 v80, 16, v84
    v_and_b32 v81, 0xffff0000, v84
    v_lshlrev_b32 v82, 16, v85
    v_and_b32 v83, 0xffff0000, v85
    v_mul_f32 v80, s50, v80
    v_mul_f32 v81, s50, v81
    v_mul_f32 v82, s50, v82
    v_mul_f32 v83, s50, v83
    v_cvt_pk_bf16_f32 v84, v80, v81
    v_cvt_pk_bf16_f32 v85, v82, v83
    s_mov_b64 exec, s[64:65]
    ds_write_b64 v17, v[84:85]
    s_mov_b64 exec, -1
    v_add_u32 v17, 0x100, v17
    s_sub_u32 s58, s58, 1
    s_cmp_lg_u32 s58, 0
    s_cbranch_scc1 L_ck
    v_mov_b32 v31, v27
    s_nop 1
    v_mov_b32_dpp v31, v27 row_ror:8 row_mask:0xf bank_mask:0xc
    v_mov_b32 v25, v31
    s_nop 1
    v_permlane32_swap_b32 v31, v25
    v_max_f32 v31, v31, v25
    v_mov_b32 v25, v31
    s_nop 1
    v_permlane16_swap_b32 v31, v25
    v_max_f32 v31, v31, v25
    v_cvt_pk_bf16_f32 v31, v31, v31
    v_and_b32 v31, 0xffff0000, v31
    v_mul_f32 v31, s50, v31
    v_cvt_pk_bf16_f32 v31, v31, v31
    v_and_b32 v31, 0xffff0000, v31
    s_lshl_b32 s48, s44, 5
    v_lshl_add_u32 v88, v13, 2, s48
    ds_write_b32 v88, v31 offset:512
    s_mov_b64 exec, 1
    ds_add_u32 v9, v11 offset:284
    s_mov_b64 exec, -1
    v_and_b32 v25, 31, v1
    v_lshlrev_b32 v25, 2, v25
    v_and_b32 v89, 1, v12
    v_lshl_add_u32 v26, v89, 8, v28
    ds_read_b64 v[144:145], v26 offset:0
    ds_read_b64 v[146:147], v26 offset:512
    ds_read_b64 v[148:149], v26 offset:1024
    ds_read_b64 v[150:151], v26 offset:1536
    ds_read_b64 v[152:153], v26 offset:2048
    ds_read_b64 v[154:155], v26 offset:2560
    ds_read_b64 v[156:157], v26 offset:3072
    ds_read_b64 v[158:159], v26 offset:3584
L_w12:
    ds_read_b32 v10, v9 offset:284
    ds_read_b32 v31, v25 offset:512
    s_waitcnt lgkmcnt(0)
    v_cmp_gt_i32 vcc, 4, v10
    s_cbranch_vccz L_w12d
    s_sub_u32 s45, s45, 1
    s_cbranch_scc1 L_w12x
    s_sleep 1
    s_branch L_w12
L_w12x:
    s_mov_b32 s45, 0
L_w12d:
    v_max_f32_dpp v31, v31, v31 row_ror:8 row_mask:0xf bank_mask:0xf
    v_mov_b32 v26, v31
    s_nop 1
    v_permlane16_swap_b32 v31, v26
    v_max_f32 v31, v31, v26
    v_mul_f32 v30, s51, v31
    v_lshlrev_b32 v176, 16, v144
    v_and_b32 v177, 0xffff0000, v144
    v_lshlrev_b32 v178, 16, v145
    v_and_b32 v179, 0xffff0000, v145
    v_lshlrev_b32 v180, 16, v146
    v_and_b32 v181, 0xffff0000, v146
    v_lshlrev_b32 v182, 16, v147
    v_and_b32 v183, 0xffff0000, v147
    v_lshlrev_b32 v184, 16, v148
    v_and_b32 v185, 0xffff0000, v148
    v_lshlrev_b32 v186, 16, v149
    v_and_b32 v187, 0xffff0000, v149
    v_lshlrev_b32 v188, 16, v150
    v_and_b32 v189, 0xffff0000, v150
    v_lshlrev_b32 v190, 16, v151
    v_and_b32 v191, 0xffff0000, v151
    v_lshlrev_b32 v192, 16, v152
    v_and_b32 v193, 0xffff0000, v152
    v_lshlrev_b32 v194, 16, v153
    v_and_b32 v195, 0xffff0000, v153
    v_lshlrev_b32 v196, 16, v154
    v_and_b32 v197, 0xffff0000, v154
    v_lshlrev_b32 v198, 16, v155
    v_and_b32 v199, 0xffff0000, v155
    v_lshlrev_b32 v200, 16, v156
    v_and_b32 v201, 0xffff0000, v156
    v_lshlrev_b32 v202, 16, v157
    v_and_b32 v203, 0xffff0000, v157
    v_lshlrev_b32 v204, 16, v158
    v_and_b32 v205, 0xffff0000, v158
    v_lshlrev_b32 v206, 16, v159
    v_and_b32 v207, 0xffff0000, v159
    v_fma_f32 v176, v176, s51, -v30
    v_fma_f32 v177, v177, s51, -v30
    v_fma_f32 v178, v178, s51, -v30
    v_fma_f32 v179, v179, s51, -v30
    v_fma_f32 v180, v180, s51, -v30
    v_fma_f32 v181, v181, s51, -v30
    v_fma_f32 v182, v182, s51, -v30
    v_fma_f32 v183, v183, s51, -v30
    v_fma_f32 v184, v184, s51, -v30
    v_fma_f32 v185, v185, s51, -v30
    v_fma_f32 v186, v186, s51, -v30
    v_fma_f32 v187, v187, s51, -v30
    v_fma_f32 v188, v188, s51, -v30
    v_fma_f32 v189, v189, s51, -v30
    v_fma_f32 v190, v190, s51, -v30
    v_fma_f32 v191, v191, s51, -v30
    v_fma_f32 v192, v192, s51, -v30
    v_fma_f32 v193, v193, s51, -v30
    v_fma_f32 v194, v194, s51, -v30
    v_fma_f32 v195, v195, s51, -v30
    v_fma_f32 v196, v196, s51, -v30
    v_fma_f32 v197, v197, s51, -v30
    v_fma_f32 v198, v198, s51, -v30
    v_fma_f32 v199, v199, s51, -v30
    v_fma_f32 v200, v200, s51, -v30
    v_fma_f32 v201, v201, s51, -v30
    v_fma_f32 v202, v202, s51, -v30
    v_fma_f32 v203, v203, s51, -v30
    v_fma_f32 v204, v204, s51, -v30
    v_fma_f32 v205, v205, s51, -v30
    v_fma_f32 v206, v206, s51, -v30
    v_fma_f32 v207, v207, s51, -v30
    v_exp_f32 v176, v176
    v_exp_f32 v177, v177
    v_exp_f32 v178, v178
    v_exp_f32 v179, v179
    v_exp_f32 v180, v180
    v_exp_f32 v181, v181
    v_exp_f32 v182, v182
    v_exp_f32 v183, v183
    v_exp_f32 v184, v184
    v_exp_f32 v185, v185
    v_exp_f32 v186, v186
    v_exp_f32 v187, v187
    v_exp_f32 v188, v188
    v_exp_f32 v189, v189
    v_exp_f32 v190, v190
    v_exp_f32 v191, v191
    v_exp_f32 v192, v192
    v_exp_f32 v193, v193
    v_exp_f32 v194, v194
    v_exp_f32 v195, v195
    v_exp_f32 v196, v196
    v_exp_f32 v197, v197
    v_exp_f32 v198, v198
    v_exp_f32 v199, v199
    v_exp_f32 v200, v200
    v_exp_f32 v201, v201
    v_exp_f32 v202, v202
    v_exp_f32 v203, v203
    v_exp_f32 v204, v204
    v_exp_f32 v205, v205
    v_exp_f32 v206, v206
    v_exp_f32 v207, v207
    v_pk_add_f32 v[176:177], v[176:177], v[180:181]
    v_pk_add_f32 v[178:179], v[178:179], v[182:183]
    v_pk_add_f32 v[176:177], v[176:177], v[184:185]
    v_pk_add_f32 v[178:179], v[178:179], v[186:187]
    v_pk_add_f32 v[176:177], v[176:177], v[188:189]
    v_pk_add_f32 v[178:179], v[178:179], v[190:191]
    v_pk_add_f32 v[176:177], v[176:177], v[192:193]
    v_pk_add_f32 v[178:179], v[178:179], v[194:195]
    v_pk_add_f32 v[176:177], v[176:177], v[196:197]
    v_pk_add_f32 v[178:179], v[178:179], v[198:199]
    v_pk_add_f32 v[176:177], v[176:177], v[200:201]
    v_pk_add_f32 v[178:179], v[178:179], v[202:203]
    v_pk_add_f32 v[176:177], v[176:177], v[204:205]
    v_pk_add_f32 v[178:179], v[178:179], v[206:207]
    v_pk_add_f32 v[176:177], v[176:177], v[178:179]
    v_add_f32 v176, v176, v177
    s_nop 1
    v_add_f32_dpp v176, v176, v176 row_ror:8 row_mask:0xf bank_mask:0xf
    v_mov_b32 v26, v176
    s_nop 1
    v_permlane32_swap_b32 v176, v26
    v_add_f32 v176, v176, v26
    v_mov_b32 v26, v176
    s_nop 1
    v_permlane16_swap_b32 v176, v26
    v_add_f32 v176, v176, v26
    ds_write_b32 v88, v176 offset:640
    s_mov_b64 exec, 1
    ds_add_u32 v9, v11 offset:288
    s_mov_b64 exec, -1
    s_mov_b32 s58, 16
L_cv:
    ds_read_b64 v[84:85], v28
    v_add_u32 v28, 0x100, v28
    s_waitcnt lgkmcnt(0)
    v_lshlrev_b32 v80, 16, v84
    v_and_b32 v81, 0xffff0000, v84
    v_lshlrev_b32 v82, 16, v85
    v_and_b32 v83, 0xffff0000, v85
    v_fma_f32 v80, v80, s51, -v30
    v_fma_f32 v81, v81, s51, -v30
    v_fma_f32 v82, v82, s51, -v30
    v_fma_f32 v83, v83, s51, -v30
    v_exp_f32 v80, v80
    v_exp_f32 v81, v81
    v_exp_f32 v82, v82
    v_exp_f32 v83, v83
    v_cvt_pk_bf16_f32 v86, v80, v81
    v_cvt_pk_bf16_f32 v87, v82, v83
    s_sub_u32 s58, s58, 1
    s_cmp_eq_u32 s58, 0
    s_cbranch_scc1 L_clast
L_w13:
    ds_read_b32 v10, v8 offset:0
    s_waitcnt lgkmcnt(0)
    v_cmp_gt_i32 vcc, s56, v10
    s_cbranch_vccz L_w13d
    s_sub_u32 s45, s45, 1
    s_cbranch_scc1 L_w13x
    s_sleep 1
    s_branch L_w13
L_w13x:
    s_mov_b32 s45, 0
L_w13d:
    ds_read_b128 v[128:131], v7 offset:0
    ds_read_b128 v[132:135], v7 offset:1024
    ds_read_b128 v[136:139], v7 offset:2048
    ds_read_b128 v[140:143], v7 offset:3072
    s_add_u32 s56, s56, 16
    s_add_u32 s57, s57, 16384
    s_and_b32 s57, s57, 0x1ffff
    v_add_u32 v19, 16, v19
    s_waitcnt lgkmcnt(0)
    ds_write_b32 v18, v19 offset:256
    v_add_u32 v7, s57, v6
    v_perm_b32 v96, v132, v128, s52
    v_perm_b32 v97, v140, v136, s52
    v_perm_b32 v98, v132, v128, s53
    v_perm_b32 v99, v140, v136, s53
    v_mfma_f32_16x16x16_bf16 v[32:35], v[86:87], v[96:97], v[32:35]
    v_perm_b32 v100, v133, v129, s52
    v_perm_b32 v101, v141, v137, s52
    v_mfma_f32_16x16x16_bf16 v[36:39], v[86:87], v[98:99], v[36:39]
    v_perm_b32 v102, v133, v129, s53
    v_perm_b32 v103, v141, v137, s53
    v_mfma_f32_16x16x16_bf16 v[40:43], v[86:87], v[100:101], v[40:43]
    v_perm_b32 v104, v134, v130, s52
    v_perm_b32 v105, v142, v138, s52
    v_mfma_f32_16x16x16_bf16 v[44:47], v[86:87], v[102:103], v[44:47]
    v_perm_b32 v106, v134, v130, s53
    v_perm_b32 v107, v142, v138, s53
    v_mfma_f32_16x16x16_bf16 v[48:51], v[86:87], v[104:105], v[48:51]
    v_perm_b32 v108, v135, v131, s52
    v_perm_b32 v109, v143, v139, s52
    v_mfma_f32_16x16x16_bf16 v[52:55], v[86:87], v[106:107], v[52:55]
    v_perm_b32 v110, v135, v131, s53
    v_perm_b32 v111, v143, v139, s53
    v_mfma_f32_16x16x16_bf16 v[56:59], v[86:87], v[108:109], v[56:59]
    s_nop 0
    v_mfma_f32_16x16x16_bf16 v[60:63], v[86:87], v[110:111], v[60:63]
    s_branch L_cv
L_clast:
L_w14:
    ds_read_b32 v10, v8 offset:0
    ds_read_b128 v[128:131], v7 offset:0
    ds_read_b128 v[132:135], v7 offset:1024
    ds_read_b128 v[136:139], v7 offset:2048
    ds_read_b128 v[140:143], v7 offset:3072
    s_waitcnt lgkmcnt(0)
    v_cmp_gt_i32 vcc, s56, v10
    s_cbranch_vccz L_w14d
    s_sub_u32 s45, s45, 1
    s_cbranch_scc1 L_w14x
    s_branch L_w14
L_w14x:
    s_mov_b32 s45, 0
L_w14d:
    v_mov_b32 v19, 0x100000
    ds_write_b32 v18, v19 offset:256
    v_perm_b32 v96, v132, v128, s52
    v_perm_b32 v97, v140, v136, s52
    v_perm_b32 v98, v132, v128, s53
    v_perm_b32 v99, v140, v136, s53
    v_mfma_f32_16x16x16_bf16 v[32:35], v[86:87], v[96:97], v[32:35]
    v_perm_b32 v100, v133, v129, s52
    v_perm_b32 v101, v141, v137, s52
    v_mfma_f32_16x16x16_bf16 v[36:39], v[86:87], v[98:99], v[36:39]
    v_perm_b32 v102, v133, v129, s53
    v_perm_b32 v103, v141, v137, s53
    v_mfma_f32_16x16x16_bf16 v[40:43], v[86:87], v[100:101], v[40:43]
    v_perm_b32 v104, v134, v130, s52
    v_perm_b32 v105, v142, v138, s52
    v_mfma_f32_16x16x16_bf16 v[44:47], v[86:87], v[102:103], v[44:47]
    v_perm_b32 v106, v134, v130, s53
    v_perm_b32 v107, v142, v138, s53
    v_mfma_f32_16x16x16_bf16 v[48:51], v[86:87], v[104:105], v[48:51]
    v_perm_b32 v108, v135, v131, s52
    v_perm_b32 v109, v143, v139, s52
    v_mfma_f32_16x16x16_bf16 v[52:55], v[86:87], v[106:107], v[52:55]
    v_perm_b32 v110, v135, v131, s53
    v_perm_b32 v111, v143, v139, s53
    v_mfma_f32_16x16x16_bf16 v[56:59], v[86:87], v[108:109], v[56:59]
    s_nop 0
    v_mfma_f32_16x16x16_bf16 v[60:63], v[86:87], v[110:111], v[60:63]
    s_mov_b32 exec_hi, 0
    ds_write_b128 v112, v[32:35] offset:0
    ds_write_b128 v112, v[36:39] offset:256
    ds_write_b128 v112, v[40:43] offset:512
    ds_write_b128 v112, v[44:47] offset:768
    ds_write_b128 v112, v[48:51] offset:1024
    ds_write_b128 v112, v[52:55] offset:1280
    ds_write_b128 v112, v[56:59] offset:1536
    ds_write_b128 v112, v[60:63] offset:1792
    s_mov_b64 exec, 1
    ds_add_u32 v9, v11 offset:296
    s_mov_b64 exec, -1
L_w15:
    ds_read_b32 v10, v9 offset:296
    ds_read_b128 v[128:131], v113 offset:0
    ds_read_b128 v[132:135], v113 offset:4096
    ds_read_b128 v[136:139], v113 offset:8192
    ds_read_b128 v[140:143], v113 offset:12288
    s_waitcnt lgkmcnt(0)
    v_cmp_gt_i32 vcc, 4, v10
    s_cbranch_vccz L_w15d
    s_sub_u32 s45, s45, 1
    s_cbranch_scc1 L_w15x
    s_branch L_w15
L_w15x:
    s_mov_b32 s45, 0
L_w15d:
    v_pk_add_f32 v[128:129], v[128:129], v[132:133]
    v_pk_add_f32 v[136:137], v[136:137], v[140:141]
    v_pk_add_f32 v[130:131], v[130:131], v[134:135]
    v_pk_add_f32 v[138:139], v[138:139], v[142:143]
    v_pk_add_f32 v[128:129], v[128:129], v[136:137]
    v_pk_add_f32 v[130:131], v[130:131], v[138:139]
    v_bfi_b32 v128, 3, v15, v128
    v_bfi_b32 v129, 3, v15, v129
    v_bfi_b32 v130, 3, v15, v130
    v_bfi_b32 v131, 3, v15, v131
    buffer_store_dwordx4 v[128:131], v114, s[32:35], s66 offen sc1
L_w16:
    ds_read_b32 v10, v9 offset:292
    ds_read_b128 v[176:179], v117 offset:1280
    ds_read_b128 v[180:183], v117 offset:1344
    ds_read_b128 v[184:187], v117 offset:1408
    ds_read_b128 v[188:191], v117 offset:1472
    s_waitcnt lgkmcnt(0)
    v_cmp_gt_i32 vcc, 1, v10
    s_cbranch_vccz L_w16d
    s_sub_u32 s45, s45, 1
    s_cbranch_scc1 L_w16x
    s_sleep 1
    s_branch L_w16
L_w16x:
    s_mov_b32 s45, 0
L_w16d:
L_w17:
    ds_read_b32 v10, v9 offset:276
    s_waitcnt lgkmcnt(0)
    v_cmp_gt_i32 vcc, 1, v10
    s_cbranch_vccz L_w17d
    s_sub_u32 s45, s45, 1
    s_cbranch_scc1 L_w17x
    s_sleep 2
    s_branch L_w17
L_w17x:
    s_mov_b32 s45, 0
L_w17d:
    v_readfirstlane_b32 s69, v10
    s_and_b32 s48, s69, 127
    s_add_u32 s48, s48, s44
    s_lshl_b32 s48, s48, 10
    v_add_u32 v118, s48, v16
    s_add_u32 s48, s48, 0x4000
    s_and_b32 s48, s48, 0x1ffff
    v_add_u32 v119, s48, v16
    s_add_u32 s48, s69, 16
    s_add_u32 s69, s69, 32
L_w18:
    ds_read_b32 v10, v8 offset:0
    s_waitcnt lgkmcnt(0)
    v_cmp_gt_i32 vcc, s48, v10
    s_cbranch_vccz L_w18d
    s_sub_u32 s45, s45, 1
    s_cbranch_scc1 L_w18x
    s_sleep 1
    s_branch L_w18
L_w18x:
    s_mov_b32 s45, 0
L_w18d:
    buffer_load_dwordx4 v[144:147], v21, s[32:35], s67 offen offset:0 sc1
    buffer_load_dwordx4 v[148:151], v21, s[32:35], s67 offen offset:1024 sc1
    buffer_load_dwordx4 v[152:155], v21, s[32:35], s67 offen offset:2048 sc1
    buffer_load_dwordx4 v[156:159], v21, s[32:35], s67 offen offset:3072 sc1
L_w19:
    ds_read_b32 v10, v8 offset:0
    s_waitcnt lgkmcnt(0)
    v_cmp_gt_i32 vcc, s69, v10
    s_cbranch_vccz L_w19d
    s_sub_u32 s45, s45, 1
    s_cbranch_scc1 L_w19x
    s_sleep 1
    s_branch L_w19
L_w19x:
    s_mov_b32 s45, 0
L_w19d:
    ds_read_b128 v[192:195], v118 offset:0
    ds_read_b128 v[196:199], v118 offset:4096
    ds_read_b128 v[200:203], v118 offset:8192
    ds_read_b128 v[204:207], v118 offset:12288
    ds_read_b128 v[208:211], v119 offset:0
    ds_read_b128 v[212:215], v119 offset:4096
    ds_read_b128 v[216:219], v119 offset:8192
    ds_read_b128 v[220:223], v119 offset:12288
    s_mov_b32 s49, 20000
L_h3poll:
    s_waitcnt vmcnt(0)
    v_xor_b32 v144, s40, v144
    v_xor_b32 v145, s40, v145
    v_xor_b32 v146, s40, v146
    v_xor_b32 v147, s40, v147
    v_xor_b32 v148, s40, v148
    v_xor_b32 v149, s40, v149
    v_xor_b32 v150, s40, v150
    v_xor_b32 v151, s40, v151
    v_xor_b32 v152, s40, v152
    v_xor_b32 v153, s40, v153
    v_xor_b32 v154, s40, v154
    v_xor_b32 v155, s40, v155
    v_xor_b32 v156, s40, v156
    v_xor_b32 v157, s40, v157
    v_xor_b32 v158, s40, v158
    v_xor_b32 v159, s40, v159
    v_or3_b32 v164, v144, v145, v146
    v_or3_b32 v164, v164, v147, v148
    v_or3_b32 v164, v164, v149, v150
    v_or3_b32 v164, v164, v151, v152
    v_or3_b32 v164, v164, v153, v154
    v_or3_b32 v164, v164, v155, v156
    v_or3_b32 v164, v164, v157, v158
    v_or_b32 v164, v164, v159
    v_and_b32 v164, 3, v164
    s_nop 1
    v_or_b32_dpp v164, v164, v164 row_ror:8 row_mask:0xf bank_mask:0xf
    s_nop 1
    v_or_b32_dpp v164, v164, v164 row_ror:4 row_mask:0xf bank_mask:0xf
    s_nop 1
    v_or_b32_dpp v164, v164, v164 row_ror:2 row_mask:0xf bank_mask:0xf
    s_nop 1
    v_or_b32_dpp v164, v164, v164 row_ror:1 row_mask:0xf bank_mask:0xf
    v_cmp_ne_u32 vcc, 0, v164
    s_cbranch_vccz L_h3done
    s_sub_u32 s49, s49, 1
    s_cbranch_scc1 L_h3done
    s_mov_b64 exec, vcc
    buffer_load_dwordx4 v[144:147], v21, s[32:35], s67 offen offset:0 sc1
    buffer_load_dwordx4 v[148:151], v21, s[32:35], s67 offen offset:1024 sc1
    buffer_load_dwordx4 v[152:155], v21, s[32:35], s67 offen offset:2048 sc1
    buffer_load_dwordx4 v[156:159], v21, s[32:35], s67 offen offset:3072 sc1
    s_branch L_h3poll
L_h3done:
    s_mov_b64 exec, -1
    v_mul_f32 v160, v144, v176
    v_mul_f32 v161, v145, v177
    v_mul_f32 v162, v146, v178
    v_mul_f32 v163, v147, v179
    v_fmac_f32 v160, v148, v180
    v_fmac_f32 v161, v149, v181
    v_fmac_f32 v162, v150, v182
    v_fmac_f32 v163, v151, v183
    v_fmac_f32 v160, v152, v184
    v_fmac_f32 v161, v153, v185
    v_fmac_f32 v162, v154, v186
    v_fmac_f32 v163, v155, v187
    v_fmac_f32 v160, v156, v188
    v_fmac_f32 v161, v157, v189
    v_fmac_f32 v162, v158, v190
    v_fmac_f32 v163, v159, v191
    v_permlane32_swap_b32 v160, v161
    s_nop 0
    v_permlane32_swap_b32 v162, v163
    v_add_f32 v160, v160, v161
    v_add_f32 v162, v162, v163
    s_nop 1
    v_permlane16_swap_b32 v160, v162
    v_add_f32 v160, v160, v162
    ds_write_b32 v115, v160 offset:2304
    s_mov_b64 exec, 1
    ds_add_u32 v9, v11 offset:300
    s_mov_b64 exec, -1
L_w20:
    ds_read_b32 v10, v9 offset:300
    ds_read_b128 v[32:35], v116 offset:2304
    ds_read_b128 v[36:39], v116 offset:2432
    ds_read_b128 v[40:43], v116 offset:2560
    ds_read_b128 v[44:47], v116 offset:2688
    ds_read_b128 v[48:51], v116 offset:2816
    ds_read_b128 v[52:55], v116 offset:2944
    ds_read_b128 v[56:59], v116 offset:3072
    ds_read_b128 v[60:63], v116 offset:3200
    s_waitcnt lgkmcnt(0)
    v_cmp_gt_i32 vcc, 4, v10
    s_cbranch_vccz L_w20d
    s_sub_u32 s45, s45, 1
    s_cbranch_scc1 L_w20x
    s_branch L_w20
L_w20x:
    s_mov_b32 s45, 0
L_w20d:
    v_pk_add_f32 v[32:33], v[32:33], v[34:35]
    v_pk_add_f32 v[36:37], v[36:37], v[38:39]
    v_pk_add_f32 v[40:41], v[40:41], v[42:43]
    v_pk_add_f32 v[44:45], v[44:45], v[46:47]
    v_pk_add_f32 v[48:49], v[48:49], v[50:51]
    v_pk_add_f32 v[52:53], v[52:53], v[54:55]
    v_pk_add_f32 v[56:57], v[56:57], v[58:59]
    v_pk_add_f32 v[60:61], v[60:61], v[62:63]
    v_add_f32 v32, v32, v33
    v_add_f32 v36, v36, v37
    v_add_f32 v40, v40, v41
    v_add_f32 v44, v44, v45
    v_add_f32 v48, v48, v49
    v_add_f32 v52, v52, v53
    v_add_f32 v56, v56, v57
    v_add_f32 v60, v60, v61
    v_cvt_pk_bf16_f32 v32, v32, v32
    v_cvt_pk_bf16_f32 v36, v36, v36
    v_cvt_pk_bf16_f32 v40, v40, v40
    v_cvt_pk_bf16_f32 v44, v44, v44
    v_cvt_pk_bf16_f32 v48, v48, v48
    v_cvt_pk_bf16_f32 v52, v52, v52
    v_cvt_pk_bf16_f32 v56, v56, v56
    v_cvt_pk_bf16_f32 v60, v60, v60
    v_and_b32 v64, v32, v2
    v_and_b32 v65, v32, v3
    v_and_b32 v66, v32, v4
    v_and_b32 v67, v32, v5
    v_and_b32 v68, v36, v2
    v_and_b32 v69, v36, v3
    v_and_b32 v70, v36, v4
    v_and_b32 v71, v36, v5
    v_mfma_f32_16x16x32_bf16 v[128:131], v[64:67], v[192:195], 0
    v_and_b32 v72, v40, v2
    v_and_b32 v73, v40, v3
    v_and_b32 v74, v40, v4
    v_and_b32 v75, v40, v5
    v_mfma_f32_16x16x32_bf16 v[128:131], v[68:71], v[196:199], v[128:131]
    v_and_b32 v76, v44, v2
    v_and_b32 v77, v44, v3
    v_and_b32 v78, v44, v4
    v_and_b32 v79, v44, v5
    v_mfma_f32_16x16x32_bf16 v[128:131], v[72:75], v[200:203], v[128:131]
    v_and_b32 v80, v48, v2
    v_and_b32 v81, v48, v3
    v_and_b32 v82, v48, v4
    v_and_b32 v83, v48, v5
    v_mfma_f32_16x16x32_bf16 v[128:131], v[76:79], v[204:207], v[128:131]
    v_and_b32 v84, v52, v2
    v_and_b32 v85, v52, v3
    v_and_b32 v86, v52, v4
    v_and_b32 v87, v52, v5
    v_mfma_f32_16x16x32_bf16 v[128:131], v[80:83], v[208:211], v[128:131]
    v_and_b32 v88, v56, v2
    v_and_b32 v89, v56, v3
    v_and_b32 v90, v56, v4
    v_and_b32 v91, v56, v5
    v_mfma_f32_16x16x32_bf16 v[128:131], v[84:87], v[212:215], v[128:131]
    v_and_b32 v92, v60, v2
    v_and_b32 v93, v60, v3
    v_and_b32 v94, v60, v4
    v_and_b32 v95, v60, v5
    v_mfma_f32_16x16x32_bf16 v[128:131], v[88:91], v[216:219], v[128:131]
    s_nop 0
    v_mfma_f32_16x16x32_bf16 v[128:131], v[92:95], v[220:223], v[128:131]
    s_nop 7
    v_mov_b32_dpp v132, v128 row_ror:8 row_mask:0xf bank_mask:0xf
    v_mov_b32_dpp v133, v129 row_ror:8 row_mask:0xf bank_mask:0xf
    v_mov_b32_dpp v134, v130 row_ror:8 row_mask:0xf bank_mask:0xf
    v_mov_b32_dpp v135, v131 row_ror:8 row_mask:0xf bank_mask:0xf
    v_permlane32_swap_b32 v132, v136
    v_permlane32_swap_b32 v133, v137
    v_permlane32_swap_b32 v134, v138
    v_permlane32_swap_b32 v135, v139
    v_add_f32 v128, v128, v136
    v_add_f32 v129, v129, v137
    v_add_f32 v130, v130, v138
    v_add_f32 v131, v131, v139
    v_add_u32 v128, 0x200, v128
    v_add_u32 v129, 0x200, v129
    v_add_u32 v130, 0x200, v130
    v_add_u32 v131, 0x200, v131
    v_bfi_b32 v128, s43, v15, v128
    v_bfi_b32 v129, s43, v15, v129
    v_bfi_b32 v130, s43, v15, v130
    v_bfi_b32 v131, s43, v15, v131
    s_mov_b32 exec_lo, s54
    s_mov_b32 exec_hi, 0
    buffer_store_dwordx4 v[128:131], v14, s[32:35], s68 offen sc1
    s_mov_b64 exec, -1
L_cend:
    s_mov_b64 exec, 1
    ds_add_u32 v9, v11 offset:300
    s_mov_b64 exec, -1
    s_cmp_eq_u32 s44, 3
    s_cbranch_scc1 L_bw0
    s_waitcnt lgkmcnt(0)
    s_branch L_fin
L_bw:
    s_waitcnt vmcnt(0)
    s_sub_u32 s44, s3, 6
L_bw0:
    s_lshl_b32 s48, s44, 2
    s_add_u32 s48, s48, 368
    v_mov_b32 v18, s48
    v_lshlrev_b32 v30, 2, v12
    s_lshr_b32 s4, s2, 3
    s_lshl_b32 s4, s4, 12
    s_add_u32 s4, s4, 392960
L_w21:
    ds_read_b32 v10, v9 offset:276
    s_waitcnt lgkmcnt(0)
    v_cmp_gt_i32 vcc, 1, v10
    s_cbranch_vccz L_w21d
    s_sub_u32 s45, s45, 1
    s_cbranch_scc1 L_w21x
    s_sleep 16
    s_branch L_w21
L_w21x:
    s_mov_b32 s45, 0
L_w21d:
    v_readfirstlane_b32 s6, v10
    s_lshl_b32 s48, s44, 4
    s_add_u32 s6, s6, s48
    s_add_u32 s6, s6, 32
L_bu:
L_w22:
    ds_read_b32 v10, v18 offset:0
    s_waitcnt lgkmcnt(0)
    v_cmp_gt_i32 vcc, 1, v10
    s_cbranch_vccz L_w22d
    s_sub_u32 s45, s45, 1
    s_cbranch_scc1 L_w22x
    s_sleep 1
    s_branch L_w22
L_w22x:
    s_mov_b32 s45, 0
L_w22d:
    v_readfirstlane_b32 s5, v10
    v_add_u32 v18, 8, v18
    s_cmp_gt_u32 s5, 16
    s_cbranch_scc1 L_bend
    s_cmp_eq_u32 s5, 0
    s_cbranch_scc1 L_bend
    s_lshl_b32 s5, s5, 8
    s_add_u32 s5, s5, s4
    s_and_b32 s48, s6, 127
    s_lshl_b32 s48, s48, 10
    v_add_u32 v31, s48, v16
    s_add_u32 s7, s6, 4
    s_add_u32 s8, s6, 16
    s_add_u32 s6, s6, 32
L_bw1:
    ds_read_b32 v25, v9 offset:304
    ds_read_b32 v10, v8 offset:0
    s_waitcnt lgkmcnt(0)
    v_cmp_gt_i32 vcc, s8, v10
    s_cbranch_vccz L_bpre
    v_cmp_eq_u32 vcc, 0, v25
    s_cbranch_vccz L_bfr
    s_sub_u32 s45, s45, 1
    s_cbranch_scc0 L_bw1
    s_mov_b32 s45, 0
L_bfr:
    ds_read_b32 v32, v30 offset:768
    ds_read_b32 v33, v30 offset:800
    ds_read_b32 v34, v30 offset:832
    ds_read_b32 v35, v30 offset:864
    ds_read_b32 v36, v30 offset:896
    ds_read_b32 v37, v30 offset:928
    ds_read_b32 v38, v30 offset:960
    ds_read_b32 v39, v30 offset:992
    ds_read_b32 v40, v30 offset:1024
    ds_read_b32 v41, v30 offset:1056
    ds_read_b32 v42, v30 offset:1088
    ds_read_b32 v43, v30 offset:1120
    ds_read_b32 v44, v30 offset:1152
    ds_read_b32 v45, v30 offset:1184
    v_mov_b32 v15, v25
    s_waitcnt lgkmcnt(0)
    v_and_b32 v64, v32, v2
    v_and_b32 v65, v32, v3
    v_and_b32 v66, v32, v4
    v_and_b32 v67, v32, v5
    v_and_b32 v68, v33, v2
    v_and_b32 v69, v33, v3
    v_and_b32 v70, v33, v4
    v_and_b32 v71, v33, v5
    v_and_b32 v72, v34, v2
    v_and_b32 v73, v34, v3
    v_and_b32 v74, v34, v4
    v_and_b32 v75, v34, v5
    v_and_b32 v76, v35, v2
    v_and_b32 v77, v35, v3
    v_and_b32 v78, v35, v4
    v_and_b32 v79, v35, v5
    v_and_b32 v80, v36, v2
    v_and_b32 v81, v36, v3
    v_and_b32 v82, v36, v4
    v_and_b32 v83, v36, v5
    v_and_b32 v84, v37, v2
    v_and_b32 v85, v37, v3
    v_and_b32 v86, v37, v4
    v_and_b32 v87, v37, v5
    v_and_b32 v88, v38, v2
    v_and_b32 v89, v38, v3
    v_and_b32 v90, v38, v4
    v_and_b32 v91, v38, v5
    v_and_b32 v92, v39, v2
    v_and_b32 v93, v39, v3
    v_and_b32 v94, v39, v4
    v_and_b32 v95, v39, v5
    v_and_b32 v96, v40, v2
    v_and_b32 v97, v40, v3
    v_and_b32 v98, v40, v4
    v_and_b32 v99, v40, v5
    v_and_b32 v100, v41, v2
    v_and_b32 v101, v41, v3
    v_and_b32 v102, v41, v4
    v_and_b32 v103, v41, v5
    v_and_b32 v104, v42, v2
    v_and_b32 v105, v42, v3
    v_and_b32 v106, v42, v4
    v_and_b32 v107, v42, v5
    v_and_b32 v108, v43, v2
    v_and_b32 v109, v43, v3
    v_and_b32 v110, v43, v4
    v_and_b32 v111, v43, v5
    v_and_b32 v112, v44, v2
    v_and_b32 v113, v44, v3
    v_and_b32 v114, v44, v4
    v_and_b32 v115, v44, v5
    v_and_b32 v116, v45, v2
    v_and_b32 v117, v45, v3
    v_and_b32 v118, v45, v4
    v_and_b32 v119, v45, v5
L_bprog:
    s_add_u32 s7, s7, 4
L_w23:
    ds_read_b32 v10, v8 offset:0
    s_waitcnt lgkmcnt(0)
    v_cmp_gt_i32 vcc, s7, v10
    s_cbranch_vccz L_w23d
    s_sub_u32 s45, s45, 1
    s_cbranch_scc1 L_w23x
    s_branch L_w23
L_w23x:
    s_mov_b32 s45, 0
L_w23d:
    v_cmp_gt_i32 vcc, s8, v10
    s_cbranch_vccnz L_bp2
    ds_read_b128 v[128:131], v31 offset:0
    ds_read_b128 v[132:135], v31 offset:1024
    ds_read_b128 v[136:139], v31 offset:2048
    ds_read_b128 v[140:143], v31 offset:3072
    ds_read_b128 v[144:147], v31 offset:4096
    ds_read_b128 v[148:151], v31 offset:5120
    ds_read_b128 v[152:155], v31 offset:6144
    ds_read_b128 v[156:159], v31 offset:7168
    ds_read_b128 v[160:163], v31 offset:8192
    ds_read_b128 v[164:167], v31 offset:9216
    ds_read_b128 v[168:171], v31 offset:10240
    ds_read_b128 v[172:175], v31 offset:11264
    ds_read_b128 v[176:179], v31 offset:12288
    ds_read_b128 v[180:183], v31 offset:13312
    s_waitcnt lgkmcnt(13)
    v_mfma_f32_16x16x32_bf16 v[48:51], v[64:67], v[128:131], 0
    s_waitcnt lgkmcnt(12)
    v_mfma_f32_16x16x32_bf16 v[48:51], v[68:71], v[132:135], v[48:51]
    s_waitcnt lgkmcnt(11)
    v_mfma_f32_16x16x32_bf16 v[48:51], v[72:75], v[136:139], v[48:51]
    s_waitcnt lgkmcnt(10)
    v_mfma_f32_16x16x32_bf16 v[48:51], v[76:79], v[140:143], v[48:51]
    s_waitcnt lgkmcnt(9)
    v_mfma_f32_16x16x32_bf16 v[48:51], v[80:83], v[144:147], v[48:51]
    s_waitcnt lgkmcnt(8)
    v_mfma_f32_16x16x32_bf16 v[48:51], v[84:87], v[148:151], v[48:51]
    s_waitcnt lgkmcnt(7)
    v_mfma_f32_16x16x32_bf16 v[48:51], v[88:91], v[152:155], v[48:51]
    s_waitcnt lgkmcnt(6)
    v_mfma_f32_16x16x32_bf16 v[48:51], v[92:95], v[156:159], v[48:51]
    s_waitcnt lgkmcnt(5)
    v_mfma_f32_16x16x32_bf16 v[48:51], v[96:99], v[160:163], v[48:51]
    s_waitcnt lgkmcnt(4)
    v_mfma_f32_16x16x32_bf16 v[48:51], v[100:103], v[164:167], v[48:51]
    s_waitcnt lgkmcnt(3)
    v_mfma_f32_16x16x32_bf16 v[48:51], v[104:107], v[168:171], v[48:51]
    s_waitcnt lgkmcnt(2)
    v_mfma_f32_16x16x32_bf16 v[48:51], v[108:111], v[172:175], v[48:51]
    s_waitcnt lgkmcnt(1)
    v_mfma_f32_16x16x32_bf16 v[48:51], v[112:115], v[176:179], v[48:51]
    s_waitcnt lgkmcnt(0)
    v_mfma_f32_16x16x32_bf16 v[48:51], v[116:119], v[180:183], v[48:51]
    s_branch L_bst
L_bp2:
    ds_read_b128 v[128:131], v31 offset:0
    ds_read_b128 v[132:135], v31 offset:1024
    ds_read_b128 v[136:139], v31 offset:2048
    ds_read_b128 v[140:143], v31 offset:3072
    ds_read_b128 v[144:147], v31 offset:4096
    ds_read_b128 v[148:151], v31 offset:5120
    ds_read_b128 v[152:155], v31 offset:6144
    ds_read_b128 v[156:159], v31 offset:7168
    s_waitcnt lgkmcnt(7)
    v_mfma_f32_16x16x32_bf16 v[48:51], v[64:67], v[128:131], 0
    s_waitcnt lgkmcnt(6)
    v_mfma_f32_16x16x32_bf16 v[48:51], v[68:71], v[132:135], v[48:51]
    s_waitcnt lgkmcnt(5)
    v_mfma_f32_16x16x32_bf16 v[48:51], v[72:75], v[136:139], v[48:51]
    s_waitcnt lgkmcnt(4)
    v_mfma_f32_16x16x32_bf16 v[48:51], v[76:79], v[140:143], v[48:51]
    s_waitcnt lgkmcnt(3)
    v_mfma_f32_16x16x32_bf16 v[48:51], v[80:83], v[144:147], v[48:51]
    s_waitcnt lgkmcnt(2)
    v_mfma_f32_16x16x32_bf16 v[48:51], v[84:87], v[148:151], v[48:51]
    s_waitcnt lgkmcnt(1)
    v_mfma_f32_16x16x32_bf16 v[48:51], v[88:91], v[152:155], v[48:51]
    s_waitcnt lgkmcnt(0)
    v_mfma_f32_16x16x32_bf16 v[48:51], v[92:95], v[156:159], v[48:51]
L_w24:
    ds_read_b32 v10, v8 offset:0
    ds_read_b128 v[160:163], v31 offset:8192
    ds_read_b128 v[164:167], v31 offset:9216
    ds_read_b128 v[168:171], v31 offset:10240
    ds_read_b128 v[172:175], v31 offset:11264
    ds_read_b128 v[176:179], v31 offset:12288
    ds_read_b128 v[180:183], v31 offset:13312
    s_waitcnt lgkmcnt(0)
    v_cmp_gt_i32 vcc, s8, v10
    s_cbranch_vccz L_w24d
    s_sub_u32 s45, s45, 1
    s_cbranch_scc1 L_w24x
    s_branch L_w24
L_w24x:
    s_mov_b32 s45, 0
L_w24d:
    v_mfma_f32_16x16x32_bf16 v[48:51], v[96:99], v[160:163], v[48:51]
    v_mfma_f32_16x16x32_bf16 v[48:51], v[100:103], v[164:167], v[48:51]
    v_mfma_f32_16x16x32_bf16 v[48:51], v[104:107], v[168:171], v[48:51]
    v_mfma_f32_16x16x32_bf16 v[48:51], v[108:111], v[172:175], v[48:51]
    v_mfma_f32_16x16x32_bf16 v[48:51], v[112:115], v[176:179], v[48:51]
    v_mfma_f32_16x16x32_bf16 v[48:51], v[116:119], v[180:183], v[48:51]
    s_branch L_bst
L_bpre:
    ds_read_b128 v[128:131], v31 offset:0
    ds_read_b128 v[132:135], v31 offset:1024
    ds_read_b128 v[136:139], v31 offset:2048
    ds_read_b128 v[140:143], v31 offset:3072
    ds_read_b128 v[144:147], v31 offset:4096
    ds_read_b128 v[148:151], v31 offset:5120
    ds_read_b128 v[152:155], v31 offset:6144
    ds_read_b128 v[156:159], v31 offset:7168
    ds_read_b128 v[160:163], v31 offset:8192
    ds_read_b128 v[164:167], v31 offset:9216
    ds_read_b128 v[168:171], v31 offset:10240
    ds_read_b128 v[172:175], v31 offset:11264
    ds_read_b128 v[176:179], v31 offset:12288
    ds_read_b128 v[180:183], v31 offset:13312
    s_waitcnt lgkmcnt(0)
L_w25:
    ds_read_b32 v10, v9 offset:304
    ds_read_b32 v32, v30 offset:768
    ds_read_b32 v33, v30 offset:800
    ds_read_b32 v34, v30 offset:832
    ds_read_b32 v35, v30 offset:864
    ds_read_b32 v36, v30 offset:896
    ds_read_b32 v37, v30 offset:928
    ds_read_b32 v38, v30 offset:960
    ds_read_b32 v39, v30 offset:992
    ds_read_b32 v40, v30 offset:1024
    ds_read_b32 v41, v30 offset:1056
    ds_read_b32 v42, v30 offset:1088
    ds_read_b32 v43, v30 offset:1120
    ds_read_b32 v44, v30 offset:1152
    ds_read_b32 v45, v30 offset:1184
    s_waitcnt lgkmcnt(0)
    v_cmp_gt_i32 vcc, 1, v10
    s_cbranch_vccz L_w25d
    s_sub_u32 s45, s45, 1
    s_cbranch_scc1 L_w25x
    s_branch L_w25
L_w25x:
    s_mov_b32 s45, 0
L_w25d:
    v_mov_b32 v15, v10
    v_and_b32 v64, v32, v2
    v_and_b32 v65, v32, v3
    v_and_b32 v66, v32, v4
    v_and_b32 v67, v32, v5
    v_and_b32 v68, v33, v2
    v_and_b32 v69, v33, v3
    v_and_b32 v70, v33, v4
    v_and_b32 v71, v33, v5
    v_mfma_f32_16x16x32_bf16 v[48:51], v[64:67], v[128:131], 0
    v_and_b32 v72, v34, v2
    v_and_b32 v73, v34, v3
    v_and_b32 v74, v34, v4
    v_and_b32 v75, v34, v5
    v_mfma_f32_16x16x32_bf16 v[48:51], v[68:71], v[132:135], v[48:51]
    v_and_b32 v76, v35, v2
    v_and_b32 v77, v35, v3
    v_and_b32 v78, v35, v4
    v_and_b32 v79, v35, v5
    v_mfma_f32_16x16x32_bf16 v[48:51], v[72:75], v[136:139], v[48:51]
    v_and_b32 v80, v36, v2
    v_and_b32 v81, v36, v3
    v_and_b32 v82, v36, v4
    v_and_b32 v83, v36, v5
    v_mfma_f32_16x16x32_bf16 v[48:51], v[76:79], v[140:143], v[48:51]
    v_and_b32 v84, v37, v2
    v_and_b32 v85, v37, v3
    v_and_b32 v86, v37, v4
    v_and_b32 v87, v37, v5
    v_mfma_f32_16x16x32_bf16 v[48:51], v[80:83], v[144:147], v[48:51]
    v_and_b32 v88, v38, v2
    v_and_b32 v89, v38, v3
    v_and_b32 v90, v38, v4
    v_and_b32 v91, v38, v5
    v_mfma_f32_16x16x32_bf16 v[48:51], v[84:87], v[148:151], v[48:51]
    v_and_b32 v92, v39, v2
    v_and_b32 v93, v39, v3
    v_and_b32 v94, v39, v4
    v_and_b32 v95, v39, v5
    v_mfma_f32_16x16x32_bf16 v[48:51], v[88:91], v[152:155], v[48:51]
    v_and_b32 v96, v40, v2
    v_and_b32 v97, v40, v3
    v_and_b32 v98, v40, v4
    v_and_b32 v99, v40, v5
    v_mfma_f32_16x16x32_bf16 v[48:51], v[92:95], v[156:159], v[48:51]
    v_and_b32 v100, v41, v2
    v_and_b32 v101, v41, v3
    v_and_b32 v102, v41, v4
    v_and_b32 v103, v41, v5
    v_mfma_f32_16x16x32_bf16 v[48:51], v[96:99], v[160:163], v[48:51]
    v_and_b32 v104, v42, v2
    v_and_b32 v105, v42, v3
    v_and_b32 v106, v42, v4
    v_and_b32 v107, v42, v5
    v_mfma_f32_16x16x32_bf16 v[48:51], v[100:103], v[164:167], v[48:51]
    v_and_b32 v108, v43, v2
    v_and_b32 v109, v43, v3
    v_and_b32 v110, v43, v4
    v_and_b32 v111, v43, v5
    v_mfma_f32_16x16x32_bf16 v[48:51], v[104:107], v[168:171], v[48:51]
    v_and_b32 v112, v44, v2
    v_and_b32 v113, v44, v3
    v_and_b32 v114, v44, v4
    v_and_b32 v115, v44, v5
    v_mfma_f32_16x16x32_bf16 v[48:51], v[108:111], v[172:175], v[48:51]
    v_and_b32 v116, v45, v2
    v_and_b32 v117, v45, v3
    v_and_b32 v118, v45, v4
    v_and_b32 v119, v45, v5
    v_mfma_f32_16x16x32_bf16 v[48:51], v[112:115], v[176:179], v[48:51]
    s_nop 0
    v_mfma_f32_16x16x32_bf16 v[48:51], v[116:119], v[180:183], v[48:51]
L_bst:
    s_nop 7
    v_mov_b32_dpp v52, v48 row_ror:8 row_mask:0xf bank_mask:0xf
    v_mov_b32_dpp v53, v49 row_ror:8 row_mask:0xf bank_mask:0xf
    v_mov_b32_dpp v54, v50 row_ror:8 row_mask:0xf bank_mask:0xf
    v_mov_b32_dpp v55, v51 row_ror:8 row_mask:0xf bank_mask:0xf
    v_permlane32_swap_b32 v52, v56
    v_permlane32_swap_b32 v53, v57
    v_permlane32_swap_b32 v54, v58
    v_permlane32_swap_b32 v55, v59
    v_add_f32 v48, v48, v56
    v_add_f32 v49, v49, v57
    v_add_f32 v50, v50, v58
    v_add_f32 v51, v51, v59
    v_add_u32 v48, 0x200, v48
    v_add_u32 v49, 0x200, v49
    v_add_u32 v50, 0x200, v50
    v_add_u32 v51, 0x200, v51
    v_bfi_b32 v48, s43, v15, v48
    v_bfi_b32 v49, s43, v15, v49
    v_bfi_b32 v50, s43, v15, v50
    v_bfi_b32 v51, s43, v15, v51
    s_mov_b32 exec_lo, s54
    s_mov_b32 exec_hi, 0
    buffer_store_dwordx4 v[48:51], v14, s[32:35], s5 offen sc1
    s_mov_b64 exec, -1
L_bend:
    s_mov_b64 exec, 1
    ds_add_u32 v9, v11 offset:308
    s_mov_b64 exec, -1
    s_cmp_eq_u32 s3, 5
    s_cbranch_scc1 L_mdend
    s_waitcnt lgkmcnt(0)
    s_branch L_fin
L_mgr:
    s_lshl_b32 s56, s47, 12
    s_lshl_b32 s48, s46, 5
    s_add_u32 s56, s56, s48
    s_add_u32 s56, s56, 65536
    v_lshrrev_b32 v28, 2, v1
    v_lshlrev_b32 v28, 11, v28
    v_and_b32 v25, 3, v1
    v_lshl_add_u32 v28, v25, 3, v28
    s_and_b32 s60, s2, 7
    s_lshl_b32 s60, s60, 5
    s_lshr_b32 s48, s2, 3
    s_add_u32 s60, s60, s48
    s_lshl_b32 s61, s60, 3
    v_mov_b32 v13, v24
    buffer_load_ushort v27, v13, s[28:31], s61 offen
    s_waitcnt vmcnt(0)
    v_add_u32 v15, 1, v112
    s_nop 0
    v_readfirstlane_b32 s41, v15
    s_and_b32 s40, s41, 3
    s_and_b32 s41, s41, 0x3ff
L_w26:
    ds_read_b32 v10, v8 offset:0
    s_waitcnt lgkmcnt(0)
    v_cmp_gt_i32 vcc, 130, v10
    s_cbranch_vccz L_w26d
    s_sub_u32 s45, s45, 1
    s_cbranch_scc1 L_w26x
    s_sleep 4
    s_branch L_w26
L_w26x:
    s_mov_b32 s45, 0
L_w26d:
    s_mov_b32 s49, 20000
L_qpoll:
    s_lshl_b32 s48, s47, 14
    buffer_load_dwordx4 v[192:195], v21, s[32:35], s48 offen offset:0 sc1
    buffer_load_dwordx4 v[196:199], v21, s[32:35], s48 offen offset:1024 sc1
    buffer_load_dwordx4 v[200:203], v21, s[32:35], s48 offen offset:2048 sc1
    buffer_load_dwordx4 v[204:207], v21, s[32:35], s48 offen offset:3072 sc1
    s_add_u32 s48, s48, 4096
    buffer_load_dwordx4 v[208:211], v21, s[32:35], s48 offen offset:0 sc1
    buffer_load_dwordx4 v[212:215], v21, s[32:35], s48 offen offset:1024 sc1
    buffer_load_dwordx4 v[216:219], v21, s[32:35], s48 offen offset:2048 sc1
    buffer_load_dwordx4 v[220:223], v21, s[32:35], s48 offen offset:3072 sc1
    s_add_u32 s48, s48, 4096
    buffer_load_dwordx4 v[224:227], v21, s[32:35], s48 offen offset:0 sc1
    buffer_load_dwordx4 v[228:231], v21, s[32:35], s48 offen offset:1024 sc1
    buffer_load_dwordx4 v[232:235], v21, s[32:35], s48 offen offset:2048 sc1
    buffer_load_dwordx4 v[236:239], v21, s[32:35], s48 offen offset:3072 sc1
    s_add_u32 s48, s48, 4096
    buffer_load_dwordx4 v[240:243], v21, s[32:35], s48 offen offset:0 sc1
    buffer_load_dwordx4 v[244:247], v21, s[32:35], s48 offen offset:1024 sc1
    buffer_load_dwordx4 v[248:251], v21, s[32:35], s48 offen offset:2048 sc1
    buffer_load_dwordx4 v[252:255], v21, s[32:35], s48 offen offset:3072 sc1
    s_waitcnt vmcnt(0)
    v_xor_b32 v192, s40, v192
    v_xor_b32 v193, s40, v193
    v_xor_b32 v194, s40, v194
    v_xor_b32 v195, s40, v195
    v_xor_b32 v196, s40, v196
    v_xor_b32 v197, s40, v197
    v_xor_b32 v198, s40, v198
    v_xor_b32 v199, s40, v199
    v_xor_b32 v200, s40, v200
    v_xor_b32 v201, s40, v201
    v_xor_b32 v202, s40, v202
    v_xor_b32 v203, s40, v203
    v_xor_b32 v204, s40, v204
    v_xor_b32 v205, s40, v205
    v_xor_b32 v206, s40, v206
    v_xor_b32 v207, s40, v207
    v_xor_b32 v208, s40, v208
    v_xor_b32 v209, s40, v209
    v_xor_b32 v210, s40, v210
    v_xor_b32 v211, s40, v211
    v_xor_b32 v212, s40, v212
    v_xor_b32 v213, s40, v213
    v_xor_b32 v214, s40, v214
    v_xor_b32 v215, s40, v215
    v_xor_b32 v216, s40, v216
    v_xor_b32 v217, s40, v217
    v_xor_b32 v218, s40, v218
    v_xor_b32 v219, s40, v219
    v_xor_b32 v220, s40, v220
    v_xor_b32 v221, s40, v221
    v_xor_b32 v222, s40, v222
    v_xor_b32 v223, s40, v223
    v_xor_b32 v224, s40, v224
    v_xor_b32 v225, s40, v225
    v_xor_b32 v226, s40, v226
    v_xor_b32 v227, s40, v227
    v_xor_b32 v228, s40, v228
    v_xor_b32 v229, s40, v229
    v_xor_b32 v230, s40, v230
    v_xor_b32 v231, s40, v231
    v_xor_b32 v232, s40, v232
    v_xor_b32 v233, s40, v233
    v_xor_b32 v234, s40, v234
    v_xor_b32 v235, s40, v235
    v_xor_b32 v236, s40, v236
    v_xor_b32 v237, s40, v237
    v_xor_b32 v238, s40, v238
    v_xor_b32 v239, s40, v239
    v_xor_b32 v240, s40, v240
    v_xor_b32 v241, s40, v241
    v_xor_b32 v242, s40, v242
    v_xor_b32 v243, s40, v243
    v_xor_b32 v244, s40, v244
    v_xor_b32 v245, s40, v245
    v_xor_b32 v246, s40, v246
    v_xor_b32 v247, s40, v247
    v_xor_b32 v248, s40, v248
    v_xor_b32 v249, s40, v249
    v_xor_b32 v250, s40, v250
    v_xor_b32 v251, s40, v251
    v_xor_b32 v252, s40, v252
    v_xor_b32 v253, s40, v253
    v_xor_b32 v254, s40, v254
    v_xor_b32 v255, s40, v255
    v_or3_b32 v32, v192, v193, v194
    v_or3_b32 v32, v32, v195, v196
    v_or3_b32 v32, v32, v197, v198
    v_or3_b32 v32, v32, v199, v200
    v_or3_b32 v32, v32, v201, v202
    v_or3_b32 v32, v32, v203, v204
    v_or3_b32 v32, v32, v205, v206
    v_or3_b32 v32, v32, v207, v208
    v_or3_b32 v32, v32, v209, v210
    v_or3_b32 v32, v32, v211, v212
    v_or3_b32 v32, v32, v213, v214
    v_or3_b32 v32, v32, v215, v216
    v_or3_b32 v32, v32, v217, v218
    v_or3_b32 v32, v32, v219, v220
    v_or3_b32 v32, v32, v221, v222
    v_or3_b32 v32, v32, v223, v224
    v_or3_b32 v32, v32, v225, v226
    v_or3_b32 v32, v32, v227, v228
    v_or3_b32 v32, v32, v229, v230
    v_or3_b32 v32, v32, v231, v232
    v_or3_b32 v32, v32, v233, v234
    v_or3_b32 v32, v32, v235, v236
    v_or3_b32 v32, v32, v237, v238
    v_or3_b32 v32, v32, v239, v240
    v_or3_b32 v32, v32, v241, v242
    v_or3_b32 v32, v32, v243, v244
    v_or3_b32 v32, v32, v245, v246
    v_or3_b32 v32, v32, v247, v248
    v_or3_b32 v32, v32, v249, v250
    v_or3_b32 v32, v32, v251, v252
    v_or3_b32 v32, v32, v253, v254
    v_or_b32 v32, v32, v255
    v_and_b32 v32, 3, v32
    v_cmp_ne_u32 vcc, 0, v32
    s_cbranch_vccz L_qdone
    s_sub_u32 s49, s49, 1
    s_cbranch_scc1 L_qdone
    s_sleep 8
    s_branch L_qpoll
L_qdone:
    v_lshlrev_b32 v25, 3, v1
    v_pk_add_f32 v[192:193], v[192:193], v[208:209]
    v_pk_add_f32 v[224:225], v[224:225], v[240:241]
    v_pk_add_f32 v[194:195], v[194:195], v[210:211]
    v_pk_add_f32 v[226:227], v[226:227], v[242:243]
    v_pk_add_f32 v[196:197], v[196:197], v[212:213]
    v_pk_add_f32 v[228:229], v[228:229], v[244:245]
    v_pk_add_f32 v[198:199], v[198:199], v[214:215]
    v_pk_add_f32 v[230:231], v[230:231], v[246:247]
    v_pk_add_f32 v[200:201], v[200:201], v[216:217]
    v_pk_add_f32 v[232:233], v[232:233], v[248:249]
    v_pk_add_f32 v[202:203], v[202:203], v[218:219]
    v_pk_add_f32 v[234:235], v[234:235], v[250:251]
    v_pk_add_f32 v[204:205], v[204:205], v[220:221]
    v_pk_add_f32 v[236:237], v[236:237], v[252:253]
    v_pk_add_f32 v[206:207], v[206:207], v[222:223]
    v_pk_add_f32 v[238:239], v[238:239], v[254:255]
    v_pk_add_f32 v[192:193], v[192:193], v[224:225]
    v_pk_add_f32 v[194:195], v[194:195], v[226:227]
    v_pk_add_f32 v[196:197], v[196:197], v[228:229]
    v_pk_add_f32 v[198:199], v[198:199], v[230:231]
    v_pk_add_f32 v[200:201], v[200:201], v[232:233]
    v_pk_add_f32 v[202:203], v[202:203], v[234:235]
    v_pk_add_f32 v[204:205], v[204:205], v[236:237]
    v_pk_add_f32 v[206:207], v[206:207], v[238:239]
    v_cvt_pk_bf16_f32 v208, v192, v193
    v_cvt_pk_bf16_f32 v209, v194, v195
    v_cvt_pk_bf16_f32 v210, v196, v197
    v_cvt_pk_bf16_f32 v211, v198, v199
    v_cvt_pk_bf16_f32 v212, v200, v201
    v_cvt_pk_bf16_f32 v213, v202, v203
    v_cvt_pk_bf16_f32 v214, v204, v205
    v_cvt_pk_bf16_f32 v215, v206, v207
    ds_write_b64 v25, v[208:209] offset:3328
    ds_write_b64 v25, v[210:211] offset:3840
    ds_write_b64 v25, v[212:213] offset:4352
    ds_write_b64 v25, v[214:215] offset:4864
    ds_write_b32 v9, v11 offset:280
    v_and_b32 v25, 31, v1
    v_lshlrev_b32 v25, 2, v25
L_w27:
    ds_read_b32 v10, v9 offset:288
    ds_read_b32 v18, v25 offset:512
    ds_read_b32 v19, v25 offset:640
    s_waitcnt lgkmcnt(0)
    v_cmp_gt_i32 vcc, 4, v10
    s_cbranch_vccz L_w27d
    s_sub_u32 s45, s45, 1
    s_cbranch_scc1 L_w27x
    s_sleep 4
    s_branch L_w27
L_w27x:
    s_mov_b32 s45, 0
L_w27d:
    v_max_f32_dpp v18, v18, v18 row_ror:8 row_mask:0xf bank_mask:0xf
    v_add_f32_dpp v19, v19, v19 row_ror:8 row_mask:0xf bank_mask:0xf
    v_mov_b32 v26, v18
    v_mov_b32 v29, v19
    s_nop 0
    v_permlane16_swap_b32 v18, v26
    v_permlane16_swap_b32 v19, v29
    v_max_f32 v18, v18, v26
    v_add_f32 v19, v19, v29
    v_bfi_b32 v18, s43, v15, v18
    s_mov_b64 exec, 0xff
    buffer_store_dwordx2 v[18:19], v28, s[32:35], s56 offen sc1
    s_mov_b64 exec, -1
L_w28:
    ds_read_b32 v10, v8 offset:0
    s_waitcnt lgkmcnt(0)
    v_cmp_gt_i32 vcc, 384, v10
    s_cbranch_vccz L_w28d
    s_sub_u32 s45, s45, 1
    s_cbranch_scc1 L_w28x
    s_sleep 8
    s_branch L_w28
L_w28x:
    s_mov_b32 s45, 0
L_w28d:
    s_lshr_b32 s48, s46, 3
    s_lshl_b32 s48, s48, 11
    s_add_u32 s48, s48, 65536
    v_lshlrev_b32 v26, 5, v1
    s_mov_b32 s49, 20000
L_wpoll:
    buffer_load_dwordx4 v[32:35], v26, s[32:35], s48 offen sc1
    buffer_load_dwordx4 v[36:39], v26, s[32:35], s48 offen offset:16 sc1
    s_waitcnt vmcnt(0)
    v_xor_b32 v32, s41, v32
    v_xor_b32 v34, s41, v34
    v_xor_b32 v36, s41, v36
    v_xor_b32 v38, s41, v38
    v_or3_b32 v40, v32, v34, v36
    v_or_b32 v40, v40, v38
    v_and_b32 v40, s43, v40
    v_cmp_ne_u32 vcc, 0, v40
    s_cbranch_vccz L_wdone
    s_sub_u32 s49, s49, 1
    s_cbranch_scc1 L_wdone
    s_mov_b64 exec, vcc
    s_sleep 8
    s_branch L_wpoll
L_wdone:
    s_mov_b64 exec, -1
    v_mov_b32 v40, v32
    v_mov_b32 v41, v34
    v_mov_b32 v42, v36
    v_mov_b32 v43, v38
    v_max_f32_dpp v40, v40, v40 row_ror:8 row_mask:0xf bank_mask:0xf
    v_max_f32_dpp v41, v41, v41 row_ror:8 row_mask:0xf bank_mask:0xf
    v_max_f32_dpp v42, v42, v42 row_ror:8 row_mask:0xf bank_mask:0xf
    v_max_f32_dpp v43, v43, v43 row_ror:8 row_mask:0xf bank_mask:0xf
    v_max_f32_dpp v40, v40, v40 row_ror:4 row_mask:0xf bank_mask:0xf
    v_max_f32_dpp v41, v41, v41 row_ror:4 row_mask:0xf bank_mask:0xf
    v_max_f32_dpp v42, v42, v42 row_ror:4 row_mask:0xf bank_mask:0xf
    v_max_f32_dpp v43, v43, v43 row_ror:4 row_mask:0xf bank_mask:0xf
    v_max_f32_dpp v40, v40, v40 row_ror:2 row_mask:0xf bank_mask:0xf
    v_max_f32_dpp v41, v41, v41 row_ror:2 row_mask:0xf bank_mask:0xf
    v_max_f32_dpp v42, v42, v42 row_ror:2 row_mask:0xf bank_mask:0xf
    v_max_f32_dpp v43, v43, v43 row_ror:2 row_mask:0xf bank_mask:0xf
    v_max_f32_dpp v40, v40, v40 row_ror:1 row_mask:0xf bank_mask:0xf
    v_max_f32_dpp v41, v41, v41 row_ror:1 row_mask:0xf bank_mask:0xf
    v_max_f32_dpp v42, v42, v42 row_ror:1 row_mask:0xf bank_mask:0xf
    v_max_f32_dpp v43, v43, v43 row_ror:1 row_mask:0xf bank_mask:0xf
    v_mov_b32 v44, v40
    v_mov_b32 v45, v41
    v_mov_b32 v46, v42
    v_mov_b32 v47, v43
    v_permlane32_swap_b32 v40, v44
    v_permlane32_swap_b32 v41, v45
    v_permlane32_swap_b32 v42, v46
    v_permlane32_swap_b32 v43, v47
    v_max_f32 v40, v40, v44
    v_max_f32 v41, v41, v45
    v_max_f32 v42, v42, v46
    v_max_f32 v43, v43, v47
    v_mov_b32 v44, v40
    v_mov_b32 v45, v41
    v_mov_b32 v46, v42
    v_mov_b32 v47, v43
    v_permlane16_swap_b32 v40, v44
    v_permlane16_swap_b32 v41, v45
    v_permlane16_swap_b32 v42, v46
    v_permlane16_swap_b32 v43, v47
    v_max_f32 v40, v40, v44
    v_max_f32 v41, v41, v45
    v_max_f32 v42, v42, v46
    v_max_f32 v43, v43, v47
    v_sub_f32 v40, v32, v40
    v_sub_f32 v41, v34, v41
    v_sub_f32 v42, v36, v42
    v_sub_f32 v43, v38, v43
    v_mul_f32 v40, s51, v40
    v_mul_f32 v41, s51, v41
    v_mul_f32 v42, s51, v42
    v_mul_f32 v43, s51, v43
    v_exp_f32 v40, v40
    v_exp_f32 v41, v41
    v_exp_f32 v42, v42
    v_exp_f32 v43, v43
    v_mul_f32 v33, v40, v33
    v_mul_f32 v35, v41, v35
    v_mul_f32 v37, v42, v37
    v_mul_f32 v39, v43, v39
    v_add_f32_dpp v33, v33, v33 row_ror:8 row_mask:0xf bank_mask:0xf
    v_add_f32_dpp v35, v35, v35 row_ror:8 row_mask:0xf bank_mask:0xf
    v_add_f32_dpp v37, v37, v37 row_ror:8 row_mask:0xf bank_mask:0xf
    v_add_f32_dpp v39, v39, v39 row_ror:8 row_mask:0xf bank_mask:0xf
    v_add_f32_dpp v33, v33, v33 row_ror:4 row_mask:0xf bank_mask:0xf
    v_add_f32_dpp v35, v35, v35 row_ror:4 row_mask:0xf bank_mask:0xf
    v_add_f32_dpp v37, v37, v37 row_ror:4 row_mask:0xf bank_mask:0xf
    v_add_f32_dpp v39, v39, v39 row_ror:4 row_mask:0xf bank_mask:0xf
    v_add_f32_dpp v33, v33, v33 row_ror:2 row_mask:0xf bank_mask:0xf
    v_add_f32_dpp v35, v35, v35 row_ror:2 row_mask:0xf bank_mask:0xf
    v_add_f32_dpp v37, v37, v37 row_ror:2 row_mask:0xf bank_mask:0xf
    v_add_f32_dpp v39, v39, v39 row_ror:2 row_mask:0xf bank_mask:0xf
    v_add_f32_dpp v33, v33, v33 row_ror:1 row_mask:0xf bank_mask:0xf
    v_add_f32_dpp v35, v35, v35 row_ror:1 row_mask:0xf bank_mask:0xf
    v_add_f32_dpp v37, v37, v37 row_ror:1 row_mask:0xf bank_mask:0xf
    v_add_f32_dpp v39, v39, v39 row_ror:1 row_mask:0xf bank_mask:0xf
    v_mov_b32 v44, v33
    v_mov_b32 v45, v35
    v_mov_b32 v46, v37
    v_mov_b32 v47, v39
    v_permlane32_swap_b32 v33, v44
    v_permlane32_swap_b32 v35, v45
    v_permlane32_swap_b32 v37, v46
    v_permlane32_swap_b32 v39, v47
    v_add_f32 v33, v33, v44
    v_add_f32 v35, v35, v45
    v_add_f32 v37, v37, v46
    v_add_f32 v39, v39, v47
    v_mov_b32 v44, v33
    v_mov_b32 v45, v35
    v_mov_b32 v46, v37
    v_mov_b32 v47, v39
    v_permlane16_swap_b32 v33, v44
    v_permlane16_swap_b32 v35, v45
    v_permlane16_swap_b32 v37, v46
    v_permlane16_swap_b32 v39, v47
    v_add_f32 v33, v33, v44
    v_add_f32 v35, v35, v45
    v_add_f32 v37, v37, v46
    v_add_f32 v39, v39, v47
    v_rcp_f32 v33, v33
    v_rcp_f32 v35, v35
    v_rcp_f32 v37, v37
    v_rcp_f32 v39, v39
    v_mul_f32 v40, v40, v33
    v_mul_f32 v41, v41, v35
    v_mul_f32 v42, v42, v37
    v_mul_f32 v43, v43, v39
    ds_write_b128 v21, v[40:43] offset:1280
    ds_write_b32 v9, v11 offset:292
    v_mov_b32 v30, 320
    s_mov_b32 s57, 544
    s_bfe_u32 s58, s2, 0x20004
    s_mul_i32 s58, s58, 28672
    s_lshl_b32 s48, s42, 8
    s_add_u32 s58, s58, s48
    s_add_u32 s58, s58, 851968
    s_mov_b32 s71, 0
    v_lshlrev_b32 v25, 7, v12
    ds_read_b128 v[64:67], v25 offset:5376
    ds_read_b128 v[68:71], v25 offset:5392
    ds_read_b128 v[72:75], v25 offset:5408
    ds_read_b128 v[76:79], v25 offset:5424
    ds_read_b128 v[80:83], v25 offset:5440
    ds_read_b128 v[84:87], v25 offset:5456
    ds_read_b128 v[88:91], v25 offset:5472
    ds_read_b128 v[92:95], v25 offset:5488
    s_waitcnt lgkmcnt(0)
    v_and_b32 v128, v64, v2
    v_and_b32 v129, v64, v3
    v_and_b32 v130, v64, v4
    v_and_b32 v131, v64, v5
    v_and_b32 v132, v65, v2
    v_and_b32 v133, v65, v3
    v_and_b32 v134, v65, v4
    v_and_b32 v135, v65, v5
    v_and_b32 v136, v66, v2
    v_and_b32 v137, v66, v3
    v_and_b32 v138, v66, v4
    v_and_b32 v139, v66, v5
    v_and_b32 v140, v67, v2
    v_and_b32 v141, v67, v3
    v_and_b32 v142, v67, v4
    v_and_b32 v143, v67, v5
    v_and_b32 v144, v68, v2
    v_and_b32 v145, v68, v3
    v_and_b32 v146, v68, v4
    v_and_b32 v147, v68, v5
    v_and_b32 v148, v69, v2
    v_and_b32 v149, v69, v3
    v_and_b32 v150, v69, v4
    v_and_b32 v151, v69, v5
    v_and_b32 v152, v70, v2
    v_and_b32 v153, v70, v3
    v_and_b32 v154, v70, v4
    v_and_b32 v155, v70, v5
    v_and_b32 v156, v71, v2
    v_and_b32 v157, v71, v3
    v_and_b32 v158, v71, v4
    v_and_b32 v159, v71, v5
    v_and_b32 v160, v72, v2
    v_and_b32 v161, v72, v3
    v_and_b32 v162, v72, v4
    v_and_b32 v163, v72, v5
    v_and_b32 v164, v73, v2
    v_and_b32 v165, v73, v3
    v_and_b32 v166, v73, v4
    v_and_b32 v167, v73, v5
    v_and_b32 v168, v74, v2
    v_and_b32 v169, v74, v3
    v_and_b32 v170, v74, v4
    v_and_b32 v171, v74, v5
    v_and_b32 v172, v75, v2
    v_and_b32 v173, v75, v3
    v_and_b32 v174, v75, v4
    v_and_b32 v175, v75, v5
    v_and_b32 v176, v76, v2
    v_and_b32 v177, v76, v3
    v_and_b32 v178, v76, v4
    v_and_b32 v179, v76, v5
    v_and_b32 v180, v77, v2
    v_and_b32 v181, v77, v3
    v_and_b32 v182, v77, v4
    v_and_b32 v183, v77, v5
    v_and_b32 v184, v78, v2
    v_and_b32 v185, v78, v3
    v_and_b32 v186, v78, v4
    v_and_b32 v187, v78, v5
    v_and_b32 v188, v79, v2
    v_and_b32 v189, v79, v3
    v_and_b32 v190, v79, v4
    v_and_b32 v191, v79, v5
    v_and_b32 v192, v80, v2
    v_and_b32 v193, v80, v3
    v_and_b32 v194, v80, v4
    v_and_b32 v195, v80, v5
    v_and_b32 v196, v81, v2
    v_and_b32 v197, v81, v3
    v_and_b32 v198, v81, v4
    v_and_b32 v199, v81, v5
    v_and_b32 v200, v82, v2
    v_and_b32 v201, v82, v3
    v_and_b32 v202, v82, v4
    v_and_b32 v203, v82, v5
    v_and_b32 v204, v83, v2
    v_and_b32 v205, v83, v3
    v_and_b32 v206, v83, v4
    v_and_b32 v207, v83, v5
    v_and_b32 v208, v84, v2
    v_and_b32 v209, v84, v3
    v_and_b32 v210, v84, v4
    v_and_b32 v211, v84, v5
    v_and_b32 v212, v85, v2
    v_and_b32 v213, v85, v3
    v_and_b32 v214, v85, v4
    v_and_b32 v215, v85, v5
    v_and_b32 v216, v86, v2
    v_and_b32 v217, v86, v3
    v_and_b32 v218, v86, v4
    v_and_b32 v219, v86, v5
    v_and_b32 v220, v87, v2
    v_and_b32 v221, v87, v3
    v_and_b32 v222, v87, v4
    v_and_b32 v223, v87, v5
    v_and_b32 v224, v88, v2
    v_and_b32 v225, v88, v3
    v_and_b32 v226, v88, v4
    v_and_b32 v227, v88, v5
    v_and_b32 v228, v89, v2
    v_and_b32 v229, v89, v3
    v_and_b32 v230, v89, v4
    v_and_b32 v231, v89, v5
    v_and_b32 v232, v90, v2
    v_and_b32 v233, v90, v3
    v_and_b32 v234, v90, v4
    v_and_b32 v235, v90, v5
    v_and_b32 v236, v91, v2
    v_and_b32 v237, v91, v3
    v_and_b32 v238, v91, v4
    v_and_b32 v239, v91, v5
    v_and_b32 v240, v92, v2
    v_and_b32 v241, v92, v3
    v_and_b32 v242, v92, v4
    v_and_b32 v243, v92, v5
    v_and_b32 v244, v93, v2
    v_and_b32 v245, v93, v3
    v_and_b32 v246, v93, v4
    v_and_b32 v247, v93, v5
    v_and_b32 v248, v94, v2
    v_and_b32 v249, v94, v3
    v_and_b32 v250, v94, v4
    v_and_b32 v251, v94, v5
    v_and_b32 v252, v95, v2
    v_and_b32 v253, v95, v3
    v_and_b32 v254, v95, v4
    v_and_b32 v255, v95, v5
L_mg:
L_w29:
    ds_read_b32 v10, v30 offset:0
    s_waitcnt lgkmcnt(0)
    v_cmp_gt_i32 vcc, 1, v10
    s_cbranch_vccz L_w29d
    s_sub_u32 s45, s45, 1
    s_cbranch_scc1 L_w29x
    s_sleep 2
    s_branch L_w29
L_w29x:
    s_mov_b32 s45, 0
L_w29d:
    v_readfirstlane_b32 s59, v10
    v_add_u32 v30, 4, v30
    s_cmp_gt_u32 s59, 28
    s_cbranch_scc1 L_mgend
    s_cmp_eq_u32 s59, 0
    s_cbranch_scc1 L_mgend
    s_mov_b32 s71, s59
    s_sub_u32 s59, s59, 1
    s_and_b32 s48, s59, 1
    s_mul_i32 s48, s48, 114688
    s_bfe_u32 s70, s59, 0x10001
    s_lshr_b32 s59, s59, 2
    s_lshl_b32 s59, s59, 8
    s_add_u32 s59, s59, s48
    s_add_u32 s59, s59, s58
    s_mul_i32 s48, s70, 14336
    s_add_u32 s59, s59, s48
    s_and_b32 s48, s57, 127
    s_lshl_b32 s48, s48, 10
    v_add_u32 v26, s48, v16
    s_add_u32 s56, s57, 12
    s_add_u32 s57, s57, 16
L_w30:
    ds_read_b32 v10, v8 offset:0
    s_waitcnt lgkmcnt(0)
    v_cmp_gt_i32 vcc, s56, v10
    s_cbranch_vccz L_w30d
    s_sub_u32 s45, s45, 1
    s_cbranch_scc1 L_w30x
    s_branch L_w30
L_w30x:
    s_mov_b32 s45, 0
L_w30d:
    ds_read_b128 v[64:67], v26 offset:0
    ds_read_b128 v[68:71], v26 offset:1024
    ds_read_b128 v[72:75], v26 offset:2048
    ds_read_b128 v[76:79], v26 offset:3072
    ds_read_b128 v[80:83], v26 offset:4096
    ds_read_b128 v[84:87], v26 offset:5120
    ds_read_b128 v[88:91], v26 offset:6144
    ds_read_b128 v[92:95], v26 offset:7168
    ds_read_b128 v[96:99], v26 offset:8192
    ds_read_b128 v[100:103], v26 offset:9216
    ds_read_b128 v[104:107], v26 offset:10240
    ds_read_b128 v[108:111], v26 offset:11264
    s_cmp_lg_u32 s70, 0
    s_cbranch_scc1 L_mh1
    s_waitcnt lgkmcnt(11)
    v_mfma_f32_16x16x32_bf16 v[48:51], v[128:131], v[64:67], 0
    s_waitcnt lgkmcnt(10)
    v_mfma_f32_16x16x32_bf16 v[48:51], v[132:135], v[68:71], v[48:51]
    s_waitcnt lgkmcnt(9)
    v_mfma_f32_16x16x32_bf16 v[48:51], v[136:139], v[72:75], v[48:51]
    s_waitcnt lgkmcnt(8)
    v_mfma_f32_16x16x32_bf16 v[48:51], v[140:143], v[76:79], v[48:51]
    s_waitcnt lgkmcnt(7)
    v_mfma_f32_16x16x32_bf16 v[48:51], v[144:147], v[80:83], v[48:51]
    s_waitcnt lgkmcnt(6)
    v_mfma_f32_16x16x32_bf16 v[48:51], v[148:151], v[84:87], v[48:51]
    s_waitcnt lgkmcnt(5)
    v_mfma_f32_16x16x32_bf16 v[48:51], v[152:155], v[88:91], v[48:51]
    s_waitcnt lgkmcnt(4)
    v_mfma_f32_16x16x32_bf16 v[48:51], v[156:159], v[92:95], v[48:51]
    s_waitcnt lgkmcnt(3)
    v_mfma_f32_16x16x32_bf16 v[48:51], v[160:163], v[96:99], v[48:51]
    s_waitcnt lgkmcnt(2)
    v_mfma_f32_16x16x32_bf16 v[48:51], v[164:167], v[100:103], v[48:51]
    s_waitcnt lgkmcnt(1)
    v_mfma_f32_16x16x32_bf16 v[48:51], v[168:171], v[104:107], v[48:51]
    s_waitcnt lgkmcnt(0)
    v_mfma_f32_16x16x32_bf16 v[48:51], v[172:175], v[108:111], v[48:51]
L_w31:
    ds_read_b32 v10, v8 offset:0
    ds_read_b128 v[112:115], v26 offset:12288
    ds_read_b128 v[116:119], v26 offset:13312
    ds_read_b128 v[120:123], v26 offset:14336
    ds_read_b128 v[124:127], v26 offset:15360
    s_waitcnt lgkmcnt(0)
    v_cmp_gt_i32 vcc, s57, v10
    s_cbranch_vccz L_w31d
    s_sub_u32 s45, s45, 1
    s_cbranch_scc1 L_w31x
    s_branch L_w31
L_w31x:
    s_mov_b32 s45, 0
L_w31d:
    v_mfma_f32_16x16x32_bf16 v[48:51], v[176:179], v[112:115], v[48:51]
    v_mfma_f32_16x16x32_bf16 v[48:51], v[180:183], v[116:119], v[48:51]
    v_mfma_f32_16x16x32_bf16 v[48:51], v[184:187], v[120:123], v[48:51]
    v_mfma_f32_16x16x32_bf16 v[48:51], v[188:191], v[124:127], v[48:51]
    s_branch L_mh2
L_mh1:
    s_waitcnt lgkmcnt(11)
    v_mfma_f32_16x16x32_bf16 v[48:51], v[192:195], v[64:67], 0
    s_waitcnt lgkmcnt(10)
    v_mfma_f32_16x16x32_bf16 v[48:51], v[196:199], v[68:71], v[48:51]
    s_waitcnt lgkmcnt(9)
    v_mfma_f32_16x16x32_bf16 v[48:51], v[200:203], v[72:75], v[48:51]
    s_waitcnt lgkmcnt(8)
    v_mfma_f32_16x16x32_bf16 v[48:51], v[204:207], v[76:79], v[48:51]
    s_waitcnt lgkmcnt(7)
    v_mfma_f32_16x16x32_bf16 v[48:51], v[208:211], v[80:83], v[48:51]
    s_waitcnt lgkmcnt(6)
    v_mfma_f32_16x16x32_bf16 v[48:51], v[212:215], v[84:87], v[48:51]
    s_waitcnt lgkmcnt(5)
    v_mfma_f32_16x16x32_bf16 v[48:51], v[216:219], v[88:91], v[48:51]
    s_waitcnt lgkmcnt(4)
    v_mfma_f32_16x16x32_bf16 v[48:51], v[220:223], v[92:95], v[48:51]
    s_waitcnt lgkmcnt(3)
    v_mfma_f32_16x16x32_bf16 v[48:51], v[224:227], v[96:99], v[48:51]
    s_waitcnt lgkmcnt(2)
    v_mfma_f32_16x16x32_bf16 v[48:51], v[228:231], v[100:103], v[48:51]
    s_waitcnt lgkmcnt(1)
    v_mfma_f32_16x16x32_bf16 v[48:51], v[232:235], v[104:107], v[48:51]
    s_waitcnt lgkmcnt(0)
    v_mfma_f32_16x16x32_bf16 v[48:51], v[236:239], v[108:111], v[48:51]
L_w32:
    ds_read_b32 v10, v8 offset:0
    ds_read_b128 v[112:115], v26 offset:12288
    ds_read_b128 v[116:119], v26 offset:13312
    ds_read_b128 v[120:123], v26 offset:14336
    ds_read_b128 v[124:127], v26 offset:15360
    s_waitcnt lgkmcnt(0)
    v_cmp_gt_i32 vcc, s57, v10
    s_cbranch_vccz L_w32d
    s_sub_u32 s45, s45, 1
    s_cbranch_scc1 L_w32x
    s_branch L_w32
L_w32x:
    s_mov_b32 s45, 0
L_w32d:
    v_mfma_f32_16x16x32_bf16 v[48:51], v[240:243], v[112:115], v[48:51]
    v_mfma_f32_16x16x32_bf16 v[48:51], v[244:247], v[116:119], v[48:51]
    v_mfma_f32_16x16x32_bf16 v[48:51], v[248:251], v[120:123], v[48:51]
    v_mfma_f32_16x16x32_bf16 v[48:51], v[252:255], v[124:127], v[48:51]
L_mh2:
    s_nop 7
    v_mov_b32_dpp v52, v48 row_ror:8 row_mask:0xf bank_mask:0xf
    v_mov_b32_dpp v53, v49 row_ror:8 row_mask:0xf bank_mask:0xf
    v_mov_b32_dpp v54, v50 row_ror:8 row_mask:0xf bank_mask:0xf
    v_mov_b32_dpp v55, v51 row_ror:8 row_mask:0xf bank_mask:0xf
    v_permlane32_swap_b32 v52, v56
    v_permlane32_swap_b32 v53, v57
    v_permlane32_swap_b32 v54, v58
    v_permlane32_swap_b32 v55, v59
    v_add_f32 v48, v48, v56
    v_add_f32 v49, v49, v57
    v_add_f32 v50, v50, v58
    v_add_f32 v51, v51, v59
    v_bfi_b32 v48, 3, v15, v48
    v_bfi_b32 v49, 3, v15, v49
    v_bfi_b32 v50, 3, v15, v50
    v_bfi_b32 v51, 3, v15, v51
    v_mov_b32 v31, s57
    ds_write_b32 v9, v31 offset:272
    s_mov_b32 exec_lo, s54
    s_mov_b32 exec_hi, 0
    buffer_store_dwordx4 v[48:51], v14, s[32:35], s59 offen sc1
    s_mov_b64 exec, -1
    s_branch L_mg
L_mgend:
    v_mov_b32 v31, 0x100000
    ds_write_b32 v9, v31 offset:272
    s_or_b32 s48, s41, 0x400
    v_mov_b32 v17, s48
    s_lshr_b32 s58, s60, 6
    s_lshl_b32 s58, s58, 16
    s_and_b32 s48, s60, 63
    s_lshl_b32 s48, s48, 4
    s_add_u32 s58, s58, s48
    s_add_u32 s58, s58, 131072
    v_lshlrev_b32 v29, 10, v1
    s_lshl_b32 s63, s60, 4
    s_add_u32 s63, s63, 393216
    v_and_b32 v25, 31, v1
    v_lshlrev_b32 v28, 12, v25
    v_lshrrev_b32 v26, 5, v1
    s_movk_i32 s48, 14336
    v_mul_u32_u24 v26, s48, v26
    v_lshl_add_u32 v26, v25, 4, v26
    v_cmp_gt_u32 s[64:65], 28, v25
    v_mov_b32 v31, 1073741824
    s_nop 0
    v_cndmask_b32 v26, v31, v26, s[64:65]
    v_cndmask_b32 v19, 0, 3, s[64:65]
    s_lshr_b32 s48, s2, 3
    s_mul_i32 s66, s48, 448
    s_add_u32 s66, s66, 851968
    s_add_u32 s67, s66, 28672
    s_add_u32 s68, s66, 57344
    s_add_u32 s69, s66, 86016
    s_lshl_b32 s70, s48, 12
    s_add_u32 s70, s70, 393216
    v_mov_b32 v30, 368
    s_cmp_gt_u32 s71, 22
    s_cselect_b32 s48, 28, 28
    s_add_u32 s48, s57, s48
L_w33:
    ds_read_b32 v10, v8 offset:0
    s_waitcnt lgkmcnt(0)
    v_cmp_gt_i32 vcc, s48, v10
    s_cbranch_vccz L_w33d
    s_sub_u32 s45, s45, 1
    s_cbranch_scc1 L_w33x
    s_sleep 2
    s_branch L_w33
L_w33x:
    s_mov_b32 s45, 0
L_w33d:
    ds_read_b32 v10, v30
    s_waitcnt lgkmcnt(0)
    v_cmp_lt_u32 vcc, 16, v10
    s_cbranch_vccnz L_mdend
    s_mov_b32 s49, 20000
L_hpoll:
    s_mov_b32 s67, s66
    buffer_load_dwordx4 v[144:147], v26, s[32:35], s67 offen sc1
    s_add_u32 s67, s67, 28672
    buffer_load_dwordx4 v[148:151], v26, s[32:35], s67 offen sc1
    s_add_u32 s67, s67, 28672
    buffer_load_dwordx4 v[152:155], v26, s[32:35], s67 offen sc1
    s_add_u32 s67, s67, 28672
    buffer_load_dwordx4 v[156:159], v26, s[32:35], s67 offen sc1
    s_add_u32 s67, s67, 28672
    buffer_load_dwordx4 v[160:163], v26, s[32:35], s67 offen sc1
    s_add_u32 s67, s67, 28672
    buffer_load_dwordx4 v[164:167], v26, s[32:35], s67 offen sc1
    s_add_u32 s67, s67, 28672
    buffer_load_dwordx4 v[168:171], v26, s[32:35], s67 offen sc1
    s_add_u32 s67, s67, 28672
    buffer_load_dwordx4 v[172:175], v26, s[32:35], s67 offen sc1
    s_waitcnt vmcnt(0)
    v_xor_b32 v144, s40, v144
    v_xor_b32 v145, s40, v145
    v_xor_b32 v146, s40, v146
    v_xor_b32 v147, s40, v147
    v_xor_b32 v148, s40, v148
    v_xor_b32 v149, s40, v149
    v_xor_b32 v150, s40, v150
    v_xor_b32 v151, s40, v151
    v_xor_b32 v152, s40, v152
    v_xor_b32 v153, s40, v153
    v_xor_b32 v154, s40, v154
    v_xor_b32 v155, s40, v155
    v_xor_b32 v156, s40, v156
    v_xor_b32 v157, s40, v157
    v_xor_b32 v158, s40, v158
    v_xor_b32 v159, s40, v159
    v_xor_b32 v160, s40, v160
    v_xor_b32 v161, s40, v161
    v_xor_b32 v162, s40, v162
    v_xor_b32 v163, s40, v163
    v_xor_b32 v164, s40, v164
    v_xor_b32 v165, s40, v165
    v_xor_b32 v166, s40, v166
    v_xor_b32 v167, s40, v167
    v_xor_b32 v168, s40, v168
    v_xor_b32 v169, s40, v169
    v_xor_b32 v170, s40, v170
    v_xor_b32 v171, s40, v171
    v_xor_b32 v172, s40, v172
    v_xor_b32 v173, s40, v173
    v_xor_b32 v174, s40, v174
    v_xor_b32 v175, s40, v175
    v_or3_b32 v32, v144, v145, v146
    v_or3_b32 v32, v32, v147, v148
    v_or3_b32 v32, v32, v149, v150
    v_or3_b32 v32, v32, v151, v152
    v_or3_b32 v32, v32, v153, v154
    v_or3_b32 v32, v32, v155, v156
    v_or3_b32 v32, v32, v157, v158
    v_or3_b32 v32, v32, v159, v160
    v_or3_b32 v32, v32, v161, v162
    v_or3_b32 v32, v32, v163, v164
    v_or3_b32 v32, v32, v165, v166
    v_or3_b32 v32, v32, v167, v168
    v_or3_b32 v32, v32, v169, v170
    v_or3_b32 v32, v32, v171, v172
    v_or3_b32 v32, v32, v173, v174
    v_or_b32 v32, v32, v175
    v_and_b32 v32, v19, v32
    s_nop 1
    v_or_b32_dpp v32, v32, v32 row_ror:8 row_mask:0xf bank_mask:0xf
    s_nop 1
    v_or_b32_dpp v32, v32, v32 row_ror:4 row_mask:0xf bank_mask:0xf
    s_nop 1
    v_or_b32_dpp v32, v32, v32 row_ror:2 row_mask:0xf bank_mask:0xf
    s_nop 1
    v_or_b32_dpp v32, v32, v32 row_ror:1 row_mask:0xf bank_mask:0xf
    v_cmp_ne_u32 vcc, 0, v32
    s_cbranch_vccz L_hdone
    s_sub_u32 s49, s49, 1
    s_cbranch_scc1 L_hdone
    s_mov_b64 exec, vcc
    s_branch L_hpoll
L_hdone:
    s_mov_b64 exec, -1
    v_pk_add_f32 v[144:145], v[144:145], v[152:153]
    v_pk_add_f32 v[146:147], v[146:147], v[154:155]
    v_pk_add_f32 v[148:149], v[148:149], v[156:157]
    v_pk_add_f32 v[150:151], v[150:151], v[158:159]
    v_pk_add_f32 v[160:161], v[160:161], v[168:169]
    v_pk_add_f32 v[162:163], v[162:163], v[170:171]
    v_pk_add_f32 v[164:165], v[164:165], v[172:173]
    v_pk_add_f32 v[166:167], v[166:167], v[174:175]
    v_pk_add_f32 v[96:97], v[144:145], v[148:149]
    v_pk_add_f32 v[98:99], v[146:147], v[150:151]
    v_pk_add_f32 v[104:105], v[160:161], v[164:165]
    v_pk_add_f32 v[106:107], v[162:163], v[166:167]
L_hdone2:
    v_permlane32_swap_b32 v96, v98
    v_permlane32_swap_b32 v97, v99
    v_permlane32_swap_b32 v104, v106
    v_permlane32_swap_b32 v105, v107
    v_pk_add_f32 v[96:97], v[96:97], v[98:99]
    v_pk_add_f32 v[104:105], v[104:105], v[106:107]
    v_cvt_pk_bf16_f32 v96, v96, v104
    v_cvt_pk_bf16_f32 v97, v97, v105
    v_and_b32 v104, 0xffff0000, v96
    v_lshlrev_b32 v96, 16, v96
    v_and_b32 v105, 0xffff0000, v97
    v_lshlrev_b32 v97, 16, v97
    v_mul_f32 v98, s51, v96
    v_mul_f32 v99, s51, v97
    v_exp_f32 v98, -v98
    v_exp_f32 v99, -v99
    v_add_f32 v98, 1.0, v98
    v_add_f32 v99, 1.0, v99
    v_rcp_f32 v98, v98
    v_rcp_f32 v99, v99
    v_mul_f32 v96, v96, v98
    v_mul_f32 v97, v97, v99
    v_cvt_pk_bf16_f32 v96, v96, v96
    v_cvt_pk_bf16_f32 v97, v97, v97
    v_and_b32 v96, 0xffff0000, v96
    v_and_b32 v97, 0xffff0000, v97
    v_mul_f32 v96, v96, v104
    v_mul_f32 v97, v97, v105
    v_cvt_pk_bf16_f32 v96, v96, v96
    v_cvt_pk_bf16_f32 v97, v97, v97
    v_lshrrev_b32 v31, 5, v1
    v_lshlrev_b32 v31, 3, v31
    v_lshl_add_u32 v31, v25, 4, v31
    ds_write_b64 v31, v[96:97] offset:768
    v_lshlrev_b32 v31, 2, v12
    ds_write_b32 v9, v17 offset:304
    s_mov_b32 s44, 2
    s_branch L_bw0
L_mdend:
    s_mov_b32 s49, 20000
L_w34:
    ds_read_b32 v10, v9 offset:300
    s_waitcnt lgkmcnt(0)
    v_cmp_gt_i32 vcc, 8, v10
    s_cbranch_vccz L_w34d
    s_sub_u32 s45, s45, 1
    s_cbranch_scc1 L_w34x
    s_branch L_w34
L_w34x:
    s_mov_b32 s45, 0
L_w34d:
L_w35:
    ds_read_b32 v10, v9 offset:308
    s_waitcnt lgkmcnt(0)
    v_cmp_gt_i32 vcc, 3, v10
    s_cbranch_vccz L_w35d
    s_sub_u32 s45, s45, 1
    s_cbranch_scc1 L_w35x
    s_branch L_w35
L_w35x:
    s_mov_b32 s45, 0
L_w35d:
L_h4poll:
    buffer_load_dwordx4 v[160:163], v29, s[32:35], s58 offen sc1
    buffer_load_dwordx4 v[164:167], v28, s[32:35], s63 offen sc1
    s_waitcnt vmcnt(0)
    v_xor_b32 v160, s41, v160
    v_xor_b32 v161, s41, v161
    v_xor_b32 v162, s41, v162
    v_xor_b32 v163, s41, v163
    v_xor_b32 v164, s41, v164
    v_xor_b32 v165, s41, v165
    v_xor_b32 v166, s41, v166
    v_xor_b32 v167, s41, v167
    v_or3_b32 v168, v160, v161, v162
    v_or3_b32 v168, v168, v163, v164
    v_or3_b32 v168, v168, v165, v166
    v_or_b32 v168, v168, v167
    v_and_b32 v168, s43, v168
    v_cmp_ne_u32 vcc, 0, v168
    s_cbranch_vccz L_h4done
    s_sub_u32 s49, s49, 1
    s_cbranch_scc1 L_h4done
    s_mov_b64 exec, vcc
    s_branch L_h4poll
L_h4done:
    s_mov_b64 exec, -1
    v_permlane32_swap_b32 v160, v161
    v_permlane32_swap_b32 v162, v163
    v_add_f32 v160, v160, v161
    v_add_f32 v162, v162, v163
    s_nop 1
    v_permlane16_swap_b32 v160, v162
    v_add_f32 v160, v160, v162
    v_permlane32_swap_b32 v164, v165
    v_permlane32_swap_b32 v166, v167
    v_add_f32 v164, v164, v165
    v_add_f32 v166, v166, v167
    s_nop 1
    v_permlane16_swap_b32 v164, v166
    v_add_f32 v164, v164, v166
    v_add_f32_dpp v160, v160, v160 row_ror:8 row_mask:0xf bank_mask:0xf
    s_nop 0
    v_add_f32_dpp v164, v164, v164 row_ror:8 row_mask:0xf bank_mask:0xf
    v_add_f32_dpp v160, v160, v160 row_ror:4 row_mask:0xf bank_mask:0xf
    s_nop 0
    v_add_f32_dpp v164, v164, v164 row_ror:4 row_mask:0xf bank_mask:0xf
    v_add_f32_dpp v160, v160, v160 row_ror:2 row_mask:0xf bank_mask:0xf
    s_nop 0
    v_add_f32_dpp v164, v164, v164 row_ror:2 row_mask:0xf bank_mask:0xf
    v_add_f32_dpp v160, v160, v160 row_ror:1 row_mask:0xf bank_mask:0xf
    s_nop 0
    v_add_f32_dpp v164, v164, v164 row_ror:1 row_mask:0xf bank_mask:0xf
    v_mul_f32 v164, 0.5, v164
    v_cvt_pk_bf16_f32 v160, v160, v164
    v_lshlrev_b32 v27, 16, v27
    v_and_b32 v164, 0xffff0000, v160
    v_lshlrev_b32 v160, 16, v160
    v_add_f32 v160, v27, v160
    v_cvt_pk_bf16_f32 v160, v160, v160
    v_and_b32 v160, 0xffff0000, v160
    v_add_f32 v160, v160, v164
    v_cvt_pk_bf16_f32 v160, v160, v160
    s_mov_b32 exec_lo, 0x00010001
    s_mov_b32 exec_hi, 0x00010001
    buffer_store_short v160, v13, s[36:39], s61 offen
    s_cmp_lg_u32 s2, 0
    s_cbranch_scc1 L_noep
    s_mov_b64 exec, 1
    buffer_store_dword v15, v9, s[32:35], s62 offen
L_noep:
L_fin:
L_end:
    s_endpgm
.section .rodata,"a"
.p2align 6
.amdhsa_kernel parallel_sum__gqa_block_cached__swiglu_ffn__decode_kernel
  .amdhsa_next_free_vgpr 256
  .amdhsa_next_free_sgpr 102
  .amdhsa_accum_offset 256
  .amdhsa_group_segment_fixed_size 0
  .amdhsa_kernarg_size 96
  .amdhsa_user_sgpr_count 2
  .amdhsa_user_sgpr_kernarg_segment_ptr 1
  .amdhsa_system_sgpr_workgroup_id_x 1
.end_amdhsa_kernel
```
